```python
import torch

def _softmax(x, axis=-1):
    return torch.softmax(x, dim=axis)
def _gelu(x):
    return torch.nn.functional.gelu(x, approximate="tanh")
def _silu(x):
    return torch.nn.functional.silu(x)
def _sigmoid(x):
    return torch.sigmoid(x)
def _layernorm(x, axis=-1, eps=1e-5):
    m = x.mean(dim=axis, keepdim=True)
    v = x.var(dim=axis, keepdim=True, unbiased=False)
    return (x - m) / torch.sqrt(v + eps)
def _scatter_add(tgt, idx, src, axis=0):
    return tgt.clone().index_add_(axis, idx, src)
def _segment_sum(src, seg, n):
    out = torch.zeros((n,) + src.shape[1:], dtype=src.dtype)
    return out.index_add_(0, seg, src)
def _pad(x, pw):
    flat = tuple(v for pair in reversed(pw) for v in pair)
    return torch.nn.functional.pad(x, flat)

kernel_name = 'sequential_preLN__mha_block__dense_activation_gelu__prompt'

def setup_inputs():

    _w = (lambda a: (lambda t: t.to(torch.bfloat16) if t.is_floating_point() else t)(torch.as_tensor(a)))
    def _A_setup():
        B, S, D, H = 1, 2048, 1024, 32
        return {
            "x": _w((lambda *s: torch.randn(*s, dtype=torch.bfloat16) * 0.05)(B, S, D)),
            "wqkv": _w((lambda *s: torch.randn(*s, dtype=torch.bfloat16) * 0.05)(D, 3 * D)),
            "wo": _w((lambda *s: torch.randn(*s, dtype=torch.bfloat16) * 0.05)(D, D)),
        }
    _A_in = _A_setup()

    def _B_setup():
        B, S, D, F = 1, 2048, 1024, 3584
        return {
            "x": _w((lambda *s: torch.randn(*s, dtype=torch.bfloat16) * 0.05)(B, S, D)),
            "w1": _w((lambda *s: torch.randn(*s, dtype=torch.bfloat16) * 3.2)(D, F) * (D ** -0.5)),
            "b1": _w((lambda *s: torch.randn(*s, dtype=torch.bfloat16) * 3.2)(F) * 0.01),
            "w2": _w((lambda *s: torch.randn(*s, dtype=torch.bfloat16) * 0.4)(F, D) * (F ** -0.5)),
            "b2": _w((lambda *s: torch.randn(*s, dtype=torch.bfloat16) * 0.4)(D) * 0.01),
        }
    _B_in = _B_setup()

    return {
        "A_x": _A_in["x"],
        "A_wqkv": _A_in["wqkv"],
        "A_wo": _A_in["wo"],
        "B_x": _B_in["x"],
        "B_w1": _B_in["w1"],
        "B_b1": _B_in["b1"],
        "B_w2": _B_in["w2"],
        "B_b2": _B_in["b2"],
    }

def reference(A_x, A_wqkv, A_wo, B_x, B_w1, B_b1, B_w2, B_b2):
    def _A_ref(x, wqkv, wo):
        B, S, D = x.shape
        H = 32
        Dh = D // H
        qkv = (lambda x, *d: x.permute(*d))((x @ wqkv).reshape(B, S, 3, H, Dh), 2, 0, 3, 1, 4)
        q, k, v = qkv[0], qkv[1], qkv[2]
        scores = torch.einsum("bhqd,bhkd->bhqk", q, k) * (Dh ** -0.5)
        p = _softmax(scores, axis=-1)
        o = torch.einsum("bhqk,bhkd->bhqd", p, v)
        return (lambda x, *d: x.permute(*d))(o, 0, 2, 1, 3).reshape(B, S, D) @ wo

    def _B_ref(x, w1, b1, w2, b2):
        h = torch.einsum("bsd,df->bsf", x, w1) + b1
        h = _gelu(h)
        return torch.einsum("bsf,fd->bsd", h, w2) + b2

    x = A_x
    h = x + _A_ref(_layernorm(x, axis=-1), A_wqkv, A_wo)
    h2 = h + _B_ref(_layernorm(h, axis=-1), B_w1, B_b1, B_w2, B_b2)
    return h2
```

```asm
; @launch grid=(256,1,1) block=(512,1,1) lds=163840
.amdgcn_target "amdgcn-amd-amdhsa--gfx950"
.text
.globl sequential_preLN__mha_block__dense_activation_gelu__prompt_kernel
.p2align 8
.type sequential_preLN__mha_block__dense_activation_gelu__prompt_kernel,@function
sequential_preLN__mha_block__dense_activation_gelu__prompt_kernel:
  s_cmp_ge_u32 s2, 256
  s_cbranch_scc1 sequential_preLN__mha_block__dense_activation_gelu__prompt_kernel_end
  s_load_dwordx2 s[4:5], s[0:1], 80
  s_load_dwordx2 s[8:9], s[0:1], 0
  s_load_dwordx2 s[12:13], s[0:1], 8
  s_load_dwordx2 s[54:55], s[0:1], 72
  v_lshrrev_b32 v1, 6, v0
  v_and_b32 v0, 63, v0
  s_nop 0
  v_readfirstlane_b32 s3, v1
  s_waitcnt lgkmcnt(0)
  s_add_u32 s4, s4, 44040192
  s_addc_u32 s5, s5, 0
  s_mov_b32 s6, 524288
  s_mov_b32 s7, 0x00020000
  s_cmp_lt_u32 s3, 4
  s_cbranch_scc1 C_qkv
  s_cmp_ge_u32 s3, 6
  s_cbranch_scc1 L_stream
  s_and_b32 s43, s2, 7
  s_lshr_b32 s44, s2, 3
  s_and_b32 s37, s43, 1
  s_mul_i32 s37, s37, 8
  s_and_b32 s45, s44, 7
  s_add_u32 s37, s37, s45
  s_lshr_b32 s38, s43, 1
  s_mul_i32 s38, s38, 4
  s_lshr_b32 s45, s44, 3
  s_add_u32 s38, s38, s45
  s_sub_u32 s43, s3, 4
  s_lshl_b32 s44, s37, 7
  s_mul_i32 s45, s43, 64
  s_add_u32 s44, s44, s45
  s_lshl_b32 s44, s44, 11
  v_lshrrev_b32 v40, 3, v0
  v_lshl_add_u32 v40, v40, 11, s44
  v_lshrrev_b32 v41, 4, v0
  v_and_b32 v42, 7, v0
  v_xor_b32 v41, v41, v42
  v_lshl_add_u32 v8, v41, 4, v40
  v_xor_b32 v41, 4, v41
  v_lshl_add_u32 v9, v41, 4, v40
  v_add_u32 v9, 16384, v9
  v_add_u32 v10, 32768, v8
  v_add_u32 v11, 32768, v9
  v_add_u32 v12, 32768, v10
  v_add_u32 v13, 32768, v11
  v_add_u32 v14, 32768, v12
  v_add_u32 v15, 32768, v13
  v_lshrrev_b32 v40, 4, v0
  s_mul_i32 s44, s43, 48
  v_add_u32 v40, s44, v40
  v_bfe_u32 v41, v0, 2, 2
  v_and_b32 v42, 3, v0
  s_mov_b32 s45, 6144
  s_lshl_b32 s44, s38, 7
  v_add_u32 v43, 0, v40
  v_mul_u32_u24 v44, 43, v43
  v_lshrrev_b32 v44, 8, v44
  v_mul_u32_u24 v45, 6, v44
  v_sub_u32 v45, v43, v45
  v_bfe_u32 v46, v44, 1, 1
  v_lshlrev_b32 v46, 1, v46
  v_xor_b32 v46, v46, v42
  v_lshl_add_u32 v46, v46, 4, s44
  v_lshl_add_u32 v44, v44, 2, v41
  v_mul_lo_u32 v44, v44, s45
  v_mul_u32_u24 v47, 43, v45
  v_lshrrev_b32 v47, 7, v47
  v_mad_i32_i24 v45, v47, -3, v45
  v_lshlrev_b32 v45, 11, v45
  v_lshl_add_u32 v45, v47, 6, v45
  v_add3_u32 v16, v44, v45, v46
  v_add_u32 v43, 4, v40
  v_mul_u32_u24 v44, 43, v43
  v_lshrrev_b32 v44, 8, v44
  v_mul_u32_u24 v45, 6, v44
  v_sub_u32 v45, v43, v45
  v_bfe_u32 v46, v44, 1, 1
  v_lshlrev_b32 v46, 1, v46
  v_xor_b32 v46, v46, v42
  v_lshl_add_u32 v46, v46, 4, s44
  v_lshl_add_u32 v44, v44, 2, v41
  v_mul_lo_u32 v44, v44, s45
  v_mul_u32_u24 v47, 43, v45
  v_lshrrev_b32 v47, 7, v47
  v_mad_i32_i24 v45, v47, -3, v45
  v_lshlrev_b32 v45, 11, v45
  v_lshl_add_u32 v45, v47, 6, v45
  v_add3_u32 v17, v44, v45, v46
  v_add_u32 v43, 8, v40
  v_mul_u32_u24 v44, 43, v43
  v_lshrrev_b32 v44, 8, v44
  v_mul_u32_u24 v45, 6, v44
  v_sub_u32 v45, v43, v45
  v_bfe_u32 v46, v44, 1, 1
  v_lshlrev_b32 v46, 1, v46
  v_xor_b32 v46, v46, v42
  v_lshl_add_u32 v46, v46, 4, s44
  v_lshl_add_u32 v44, v44, 2, v41
  v_mul_lo_u32 v44, v44, s45
  v_mul_u32_u24 v47, 43, v45
  v_lshrrev_b32 v47, 7, v47
  v_mad_i32_i24 v45, v47, -3, v45
  v_lshlrev_b32 v45, 11, v45
  v_lshl_add_u32 v45, v47, 6, v45
  v_add3_u32 v18, v44, v45, v46
  v_xor_b32 v19, 32, v16
  v_add_u32 v19, 49152, v19
  v_xor_b32 v20, 32, v17
  v_add_u32 v20, 49152, v20
  v_xor_b32 v21, 32, v18
  v_add_u32 v21, 49152, v21
  v_xor_b32 v22, 32, v19
  v_add_u32 v22, 49152, v22
  v_xor_b32 v23, 32, v20
  v_add_u32 v23, 49152, v23
  v_xor_b32 v24, 32, v21
  v_add_u32 v24, 49152, v24
  v_xor_b32 v25, 32, v22
  v_add_u32 v25, 49152, v25
  v_xor_b32 v26, 32, v23
  v_add_u32 v26, 49152, v26
  v_xor_b32 v27, 32, v24
  v_add_u32 v27, 49152, v27
  s_mul_i32 s46, s43, 8192
  s_mul_i32 s47, s43, 12288
  s_add_u32 s47, s47, 16384
  s_mov_b32 s41, 0
  s_mov_b32 s42, 0
  s_add_u32 s34, s41, 2048
  s_add_u32 s35, s42, 6291456
  s_and_b32 s44, s37, 7
  s_mul_i32 s44, s44, 2
  s_and_b32 s45, s38, 7
  s_cmp_eq_u32 s45, 3
  s_cselect_b32 s44, s44, 0
  s_mul_i32 s45, s44, 128
  s_add_u32 s41, s41, s45
  s_mul_i32 s45, s44, 393216
  s_add_u32 s42, s42, s45
  s_waitcnt lgkmcnt(0)
  s_mov_b32 s10, 4194304
  s_mov_b32 s11, 0x00020000
  s_mov_b32 s14, 6291456
  s_mov_b32 s15, 0x00020000
  s_mov_b32 s39, 0
  s_mov_b32 s40, 2
qkv_lpro:
  s_add_u32 m0, s39, s46
  s_nop 0
  buffer_load_dwordx4 v8, s[8:11], s41 offen lds
  s_add_u32 m0, m0, 1024
  s_nop 0
  buffer_load_dwordx4 v9, s[8:11], s41 offen lds
  s_add_u32 m0, m0, 1024
  s_nop 0
  buffer_load_dwordx4 v10, s[8:11], s41 offen lds
  s_add_u32 m0, m0, 1024
  s_nop 0
  buffer_load_dwordx4 v11, s[8:11], s41 offen lds
  s_add_u32 m0, m0, 1024
  s_nop 0
  buffer_load_dwordx4 v12, s[8:11], s41 offen lds
  s_add_u32 m0, m0, 1024
  s_nop 0
  buffer_load_dwordx4 v13, s[8:11], s41 offen lds
  s_add_u32 m0, m0, 1024
  s_nop 0
  buffer_load_dwordx4 v14, s[8:11], s41 offen lds
  s_add_u32 m0, m0, 1024
  s_nop 0
  buffer_load_dwordx4 v15, s[8:11], s41 offen lds
  s_add_u32 s41, s41, 128
  s_cmp_eq_u32 s41, s34
  s_cselect_b32 s44, 2048, 0
  s_sub_u32 s41, s41, s44
  s_add_u32 m0, s39, s47
  s_nop 0
  buffer_load_dwordx4 v16, s[12:15], s42 offen lds
  s_add_u32 m0, m0, 1024
  s_nop 0
  buffer_load_dwordx4 v17, s[12:15], s42 offen lds
  s_add_u32 m0, m0, 1024
  s_nop 0
  buffer_load_dwordx4 v18, s[12:15], s42 offen lds
  s_add_u32 m0, m0, 1024
  s_nop 0
  buffer_load_dwordx4 v19, s[12:15], s42 offen lds
  s_add_u32 m0, m0, 1024
  s_nop 0
  buffer_load_dwordx4 v20, s[12:15], s42 offen lds
  s_add_u32 m0, m0, 1024
  s_nop 0
  buffer_load_dwordx4 v21, s[12:15], s42 offen lds
  s_add_u32 m0, m0, 1024
  s_nop 0
  buffer_load_dwordx4 v22, s[12:15], s42 offen lds
  s_add_u32 m0, m0, 1024
  s_nop 0
  buffer_load_dwordx4 v23, s[12:15], s42 offen lds
  s_add_u32 m0, m0, 1024
  s_nop 0
  buffer_load_dwordx4 v24, s[12:15], s42 offen lds
  s_add_u32 m0, m0, 1024
  s_nop 0
  buffer_load_dwordx4 v25, s[12:15], s42 offen lds
  s_add_u32 m0, m0, 1024
  s_nop 0
  buffer_load_dwordx4 v26, s[12:15], s42 offen lds
  s_add_u32 m0, m0, 1024
  s_nop 0
  buffer_load_dwordx4 v27, s[12:15], s42 offen lds
  s_add_u32 s42, s42, 393216
  s_cmp_eq_u32 s42, s35
  s_cselect_b32 s44, 6291456, 0
  s_sub_u32 s42, s42, s44
  s_add_u32 s39, s39, 40960
  s_cmp_eq_u32 s39, 122880
  s_cselect_b32 s39, 0, s39
  s_sub_u32 s40, s40, 1
  s_cmp_lg_u32 s40, 0
  s_cbranch_scc1 qkv_lpro
  s_mov_b32 s40, 14
qkv_lmain:
  s_waitcnt vmcnt(20)
  s_barrier
  s_add_u32 m0, s39, s46
  s_nop 0
  buffer_load_dwordx4 v8, s[8:11], s41 offen lds
  s_add_u32 m0, m0, 1024
  s_nop 0
  buffer_load_dwordx4 v9, s[8:11], s41 offen lds
  s_add_u32 m0, m0, 1024
  s_nop 0
  buffer_load_dwordx4 v10, s[8:11], s41 offen lds
  s_add_u32 m0, m0, 1024
  s_nop 0
  buffer_load_dwordx4 v11, s[8:11], s41 offen lds
  s_add_u32 m0, m0, 1024
  s_nop 0
  buffer_load_dwordx4 v12, s[8:11], s41 offen lds
  s_add_u32 m0, m0, 1024
  s_nop 0
  buffer_load_dwordx4 v13, s[8:11], s41 offen lds
  s_add_u32 m0, m0, 1024
  s_nop 0
  buffer_load_dwordx4 v14, s[8:11], s41 offen lds
  s_add_u32 m0, m0, 1024
  s_nop 0
  buffer_load_dwordx4 v15, s[8:11], s41 offen lds
  s_add_u32 s41, s41, 128
  s_cmp_eq_u32 s41, s34
  s_cselect_b32 s44, 2048, 0
  s_sub_u32 s41, s41, s44
  s_add_u32 m0, s39, s47
  s_nop 0
  buffer_load_dwordx4 v16, s[12:15], s42 offen lds
  s_add_u32 m0, m0, 1024
  s_nop 0
  buffer_load_dwordx4 v17, s[12:15], s42 offen lds
  s_add_u32 m0, m0, 1024
  s_nop 0
  buffer_load_dwordx4 v18, s[12:15], s42 offen lds
  s_add_u32 m0, m0, 1024
  s_nop 0
  buffer_load_dwordx4 v19, s[12:15], s42 offen lds
  s_add_u32 m0, m0, 1024
  s_nop 0
  buffer_load_dwordx4 v20, s[12:15], s42 offen lds
  s_add_u32 m0, m0, 1024
  s_nop 0
  buffer_load_dwordx4 v21, s[12:15], s42 offen lds
  s_add_u32 m0, m0, 1024
  s_nop 0
  buffer_load_dwordx4 v22, s[12:15], s42 offen lds
  s_add_u32 m0, m0, 1024
  s_nop 0
  buffer_load_dwordx4 v23, s[12:15], s42 offen lds
  s_add_u32 m0, m0, 1024
  s_nop 0
  buffer_load_dwordx4 v24, s[12:15], s42 offen lds
  s_add_u32 m0, m0, 1024
  s_nop 0
  buffer_load_dwordx4 v25, s[12:15], s42 offen lds
  s_add_u32 m0, m0, 1024
  s_nop 0
  buffer_load_dwordx4 v26, s[12:15], s42 offen lds
  s_add_u32 m0, m0, 1024
  s_nop 0
  buffer_load_dwordx4 v27, s[12:15], s42 offen lds
  s_add_u32 s42, s42, 393216
  s_cmp_eq_u32 s42, s35
  s_cselect_b32 s44, 6291456, 0
  s_sub_u32 s42, s42, s44
  s_add_u32 s39, s39, 40960
  s_cmp_eq_u32 s39, 122880
  s_cselect_b32 s39, 0, s39
  s_sub_u32 s40, s40, 1
  s_cmp_lg_u32 s40, 0
  s_cbranch_scc1 qkv_lmain
  s_waitcnt vmcnt(20)
  s_barrier
  s_waitcnt vmcnt(0)
  s_barrier
  s_branch L_qkv_end
C_qkv:
  s_load_dwordx2 s[16:17], s[0:1], 80
  s_and_b32 s43, s2, 7
  s_lshr_b32 s44, s2, 3
  s_and_b32 s37, s43, 1
  s_mul_i32 s37, s37, 8
  s_and_b32 s45, s44, 7
  s_add_u32 s37, s37, s45
  s_lshr_b32 s38, s43, 1
  s_mul_i32 s38, s38, 4
  s_lshr_b32 s45, s44, 3
  s_add_u32 s38, s38, s45
  s_lshr_b32 s43, s3, 1
  s_mul_i32 s43, s43, 8192
  v_lshl_add_u32 v8, v0, 4, s43
  v_lshrrev_b32 v1, 4, v0
  v_mul_u32_u24 v9, 3072, v1
  v_bfe_u32 v1, v0, 2, 2
  v_lshl_add_u32 v9, v1, 6, v9
  v_and_b32 v1, 3, v0
  v_lshl_add_u32 v9, v1, 3, v9
  v_add_u32 v9, 16384, v9
  v_bfe_u32 v1, v0, 4, 1
  v_lshlrev_b32 v1, 5, v1
  s_and_b32 s43, s3, 1
  s_mul_i32 s44, s43, 768
  v_xor_b32 v2, 32, v1
  v_add3_u32 v10, v9, v2, s44
  v_add3_u32 v9, v9, v1, s44
  s_lshr_b32 s44, s3, 1
  s_lshl_b32 s44, s44, 13
  v_and_b32 v1, 15, v0
  v_lshrrev_b32 v2, 1, v1
  v_lshrrev_b32 v3, 4, v0
  v_xor_b32 v2, v2, v3
  v_lshlrev_b32 v2, 4, v2
  v_lshl_add_u32 v2, v1, 7, v2
  v_add_u32 v8, s44, v2
  v_xor_b32 v11, 64, v8
  v_mov_b32 v32, 0
  v_mov_b32 v33, 0
  v_mov_b32 v34, 0
  v_mov_b32 v35, 0
  s_nop 1
  v_mfma_f32_32x32x16_bf16 v[128:143], v[32:35], v[32:35], 0
  v_mfma_f32_32x32x16_bf16 v[144:159], v[32:35], v[32:35], 0
  v_mfma_f32_32x32x16_bf16 v[160:175], v[32:35], v[32:35], 0
  v_mfma_f32_32x32x16_bf16 v[176:191], v[32:35], v[32:35], 0
  v_mfma_f32_32x32x16_bf16 v[192:207], v[32:35], v[32:35], 0
  v_mfma_f32_32x32x16_bf16 v[208:223], v[32:35], v[32:35], 0
  s_waitcnt lgkmcnt(0)
  s_add_u32 s16, s16, 4194304
  s_addc_u32 s17, s17, 0
  s_mov_b32 s18, 12582912
  s_mov_b32 s19, 0x00020000
  s_mov_b32 s39, 0
  s_barrier
  v_add_u32 v12, s39, v8
  v_add_u32 v13, s39, v9
  v_add_u32 v14, s39, v10
  v_add_u32 v15, s39, v11
  s_add_u32 s39, s39, 40960
  s_cmp_eq_u32 s39, 122880
  s_cselect_b32 s39, 0, s39
  ds_read_b128 v[32:35], v12 offset:0
  ds_read_b128 v[36:39], v12 offset:2048
  ds_read_b128 v[40:43], v12 offset:4096
  ds_read_b128 v[44:47], v12 offset:6144
  ds_read_b64_tr_b16 v[48:49], v13 offset:0
  ds_read_b64_tr_b16 v[50:51], v13 offset:1536
  ds_read_b64_tr_b16 v[52:53], v14 offset:0
  ds_read_b64_tr_b16 v[54:55], v14 offset:1536
  ds_read_b64_tr_b16 v[56:57], v13 offset:256
  ds_read_b64_tr_b16 v[58:59], v13 offset:1792
  ds_read_b64_tr_b16 v[60:61], v14 offset:256
  ds_read_b64_tr_b16 v[62:63], v14 offset:1792
  ds_read_b64_tr_b16 v[64:65], v13 offset:512
  ds_read_b64_tr_b16 v[66:67], v13 offset:2048
  ds_read_b64_tr_b16 v[68:69], v14 offset:512
  ds_read_b64_tr_b16 v[70:71], v14 offset:2048
  s_mov_b32 s40, 8
  s_branch qkv_c1
.p2align 6
qkv_cloop:
  s_waitcnt lgkmcnt(0)
  s_barrier
  v_mfma_f32_16x16x32_bf16 v[128:131], v[88:91], v[72:75], v[128:131]
  ds_read_b128 v[32:35], v12 offset:0
  v_mfma_f32_16x16x32_bf16 v[132:135], v[88:91], v[76:79], v[132:135]
  ds_read_b128 v[36:39], v12 offset:2048
  v_mfma_f32_16x16x32_bf16 v[136:139], v[88:91], v[80:83], v[136:139]
  ds_read_b128 v[40:43], v12 offset:4096
  v_mfma_f32_16x16x32_bf16 v[140:143], v[88:91], v[84:87], v[140:143]
  ds_read_b128 v[44:47], v12 offset:6144
  v_mfma_f32_16x16x32_bf16 v[144:147], v[92:95], v[72:75], v[144:147]
  ds_read_b64_tr_b16 v[48:49], v13 offset:0
  v_mfma_f32_16x16x32_bf16 v[148:151], v[92:95], v[76:79], v[148:151]
  ds_read_b64_tr_b16 v[50:51], v13 offset:1536
  v_mfma_f32_16x16x32_bf16 v[152:155], v[92:95], v[80:83], v[152:155]
  ds_read_b64_tr_b16 v[52:53], v14 offset:0
  v_mfma_f32_16x16x32_bf16 v[156:159], v[92:95], v[84:87], v[156:159]
  ds_read_b64_tr_b16 v[54:55], v14 offset:1536
  v_mfma_f32_16x16x32_bf16 v[160:163], v[96:99], v[72:75], v[160:163]
  ds_read_b64_tr_b16 v[56:57], v13 offset:256
  v_mfma_f32_16x16x32_bf16 v[164:167], v[96:99], v[76:79], v[164:167]
  ds_read_b64_tr_b16 v[58:59], v13 offset:1792
  v_mfma_f32_16x16x32_bf16 v[168:171], v[96:99], v[80:83], v[168:171]
  ds_read_b64_tr_b16 v[60:61], v14 offset:256
  v_mfma_f32_16x16x32_bf16 v[172:175], v[96:99], v[84:87], v[172:175]
  ds_read_b64_tr_b16 v[62:63], v14 offset:1792
  v_mfma_f32_16x16x32_bf16 v[176:179], v[100:103], v[72:75], v[176:179]
  ds_read_b64_tr_b16 v[64:65], v13 offset:512
  v_mfma_f32_16x16x32_bf16 v[180:183], v[100:103], v[76:79], v[180:183]
  ds_read_b64_tr_b16 v[66:67], v13 offset:2048
  v_mfma_f32_16x16x32_bf16 v[184:187], v[100:103], v[80:83], v[184:187]
  ds_read_b64_tr_b16 v[68:69], v14 offset:512
  v_mfma_f32_16x16x32_bf16 v[188:191], v[100:103], v[84:87], v[188:191]
  ds_read_b64_tr_b16 v[70:71], v14 offset:2048
  v_mfma_f32_16x16x32_bf16 v[192:195], v[72:75], v[104:107], v[192:195]
  v_mfma_f32_16x16x32_bf16 v[196:199], v[76:79], v[104:107], v[196:199]
  v_mfma_f32_16x16x32_bf16 v[200:203], v[80:83], v[104:107], v[200:203]
  v_mfma_f32_16x16x32_bf16 v[204:207], v[84:87], v[104:107], v[204:207]
  v_mfma_f32_16x16x32_bf16 v[208:211], v[72:75], v[108:111], v[208:211]
  v_mfma_f32_16x16x32_bf16 v[212:215], v[76:79], v[108:111], v[212:215]
  v_mfma_f32_16x16x32_bf16 v[216:219], v[80:83], v[108:111], v[216:219]
  v_mfma_f32_16x16x32_bf16 v[220:223], v[84:87], v[108:111], v[220:223]
qkv_c1:
  s_waitcnt lgkmcnt(0)
  v_mfma_f32_16x16x32_bf16 v[128:131], v[48:51], v[32:35], v[128:131]
  ds_read_b128 v[72:75], v15 offset:0
  v_mfma_f32_16x16x32_bf16 v[132:135], v[48:51], v[36:39], v[132:135]
  ds_read_b128 v[76:79], v15 offset:2048
  v_mfma_f32_16x16x32_bf16 v[136:139], v[48:51], v[40:43], v[136:139]
  ds_read_b128 v[80:83], v15 offset:4096
  v_mfma_f32_16x16x32_bf16 v[140:143], v[48:51], v[44:47], v[140:143]
  ds_read_b128 v[84:87], v15 offset:6144
  v_mfma_f32_16x16x32_bf16 v[144:147], v[52:55], v[32:35], v[144:147]
  ds_read_b64_tr_b16 v[88:89], v13 offset:12288
  v_mfma_f32_16x16x32_bf16 v[148:151], v[52:55], v[36:39], v[148:151]
  ds_read_b64_tr_b16 v[90:91], v13 offset:13824
  v_mfma_f32_16x16x32_bf16 v[152:155], v[52:55], v[40:43], v[152:155]
  ds_read_b64_tr_b16 v[92:93], v14 offset:12288
  v_mfma_f32_16x16x32_bf16 v[156:159], v[52:55], v[44:47], v[156:159]
  ds_read_b64_tr_b16 v[94:95], v14 offset:13824
  v_mfma_f32_16x16x32_bf16 v[160:163], v[56:59], v[32:35], v[160:163]
  ds_read_b64_tr_b16 v[96:97], v13 offset:12544
  v_mfma_f32_16x16x32_bf16 v[164:167], v[56:59], v[36:39], v[164:167]
  ds_read_b64_tr_b16 v[98:99], v13 offset:14080
  v_mfma_f32_16x16x32_bf16 v[168:171], v[56:59], v[40:43], v[168:171]
  ds_read_b64_tr_b16 v[100:101], v14 offset:12544
  v_mfma_f32_16x16x32_bf16 v[172:175], v[56:59], v[44:47], v[172:175]
  ds_read_b64_tr_b16 v[102:103], v14 offset:14080
  v_mfma_f32_16x16x32_bf16 v[176:179], v[60:63], v[32:35], v[176:179]
  ds_read_b64_tr_b16 v[104:105], v13 offset:12800
  v_mfma_f32_16x16x32_bf16 v[180:183], v[60:63], v[36:39], v[180:183]
  ds_read_b64_tr_b16 v[106:107], v13 offset:14336
  v_mfma_f32_16x16x32_bf16 v[184:187], v[60:63], v[40:43], v[184:187]
  ds_read_b64_tr_b16 v[108:109], v14 offset:12800
  v_mfma_f32_16x16x32_bf16 v[188:191], v[60:63], v[44:47], v[188:191]
  ds_read_b64_tr_b16 v[110:111], v14 offset:14336
  v_mfma_f32_16x16x32_bf16 v[192:195], v[32:35], v[64:67], v[192:195]
  v_add_u32 v16, s39, v8
  v_mfma_f32_16x16x32_bf16 v[196:199], v[36:39], v[64:67], v[196:199]
  v_add_u32 v17, s39, v9
  v_mfma_f32_16x16x32_bf16 v[200:203], v[40:43], v[64:67], v[200:203]
  v_add_u32 v18, s39, v10
  v_mfma_f32_16x16x32_bf16 v[204:207], v[44:47], v[64:67], v[204:207]
  v_add_u32 v19, s39, v11
  v_mfma_f32_16x16x32_bf16 v[208:211], v[32:35], v[68:71], v[208:211]
  s_add_u32 s39, s39, 40960
  v_mfma_f32_16x16x32_bf16 v[212:215], v[36:39], v[68:71], v[212:215]
  s_cmp_eq_u32 s39, 122880
  v_mfma_f32_16x16x32_bf16 v[216:219], v[40:43], v[68:71], v[216:219]
  s_cselect_b32 s39, 0, s39
  v_mfma_f32_16x16x32_bf16 v[220:223], v[44:47], v[68:71], v[220:223]
  s_waitcnt lgkmcnt(0)
  s_barrier
  v_mfma_f32_16x16x32_bf16 v[128:131], v[88:91], v[72:75], v[128:131]
  ds_read_b128 v[32:35], v16 offset:0
  v_mfma_f32_16x16x32_bf16 v[132:135], v[88:91], v[76:79], v[132:135]
  ds_read_b128 v[36:39], v16 offset:2048
  v_mfma_f32_16x16x32_bf16 v[136:139], v[88:91], v[80:83], v[136:139]
  ds_read_b128 v[40:43], v16 offset:4096
  v_mfma_f32_16x16x32_bf16 v[140:143], v[88:91], v[84:87], v[140:143]
  ds_read_b128 v[44:47], v16 offset:6144
  v_mfma_f32_16x16x32_bf16 v[144:147], v[92:95], v[72:75], v[144:147]
  ds_read_b64_tr_b16 v[48:49], v17 offset:0
  v_mfma_f32_16x16x32_bf16 v[148:151], v[92:95], v[76:79], v[148:151]
  ds_read_b64_tr_b16 v[50:51], v17 offset:1536
  v_mfma_f32_16x16x32_bf16 v[152:155], v[92:95], v[80:83], v[152:155]
  ds_read_b64_tr_b16 v[52:53], v18 offset:0
  v_mfma_f32_16x16x32_bf16 v[156:159], v[92:95], v[84:87], v[156:159]
  ds_read_b64_tr_b16 v[54:55], v18 offset:1536
  v_mfma_f32_16x16x32_bf16 v[160:163], v[96:99], v[72:75], v[160:163]
  ds_read_b64_tr_b16 v[56:57], v17 offset:256
  v_mfma_f32_16x16x32_bf16 v[164:167], v[96:99], v[76:79], v[164:167]
  ds_read_b64_tr_b16 v[58:59], v17 offset:1792
  v_mfma_f32_16x16x32_bf16 v[168:171], v[96:99], v[80:83], v[168:171]
  ds_read_b64_tr_b16 v[60:61], v18 offset:256
  v_mfma_f32_16x16x32_bf16 v[172:175], v[96:99], v[84:87], v[172:175]
  ds_read_b64_tr_b16 v[62:63], v18 offset:1792
  v_mfma_f32_16x16x32_bf16 v[176:179], v[100:103], v[72:75], v[176:179]
  ds_read_b64_tr_b16 v[64:65], v17 offset:512
  v_mfma_f32_16x16x32_bf16 v[180:183], v[100:103], v[76:79], v[180:183]
  ds_read_b64_tr_b16 v[66:67], v17 offset:2048
  v_mfma_f32_16x16x32_bf16 v[184:187], v[100:103], v[80:83], v[184:187]
  ds_read_b64_tr_b16 v[68:69], v18 offset:512
  v_mfma_f32_16x16x32_bf16 v[188:191], v[100:103], v[84:87], v[188:191]
  ds_read_b64_tr_b16 v[70:71], v18 offset:2048
  v_mfma_f32_16x16x32_bf16 v[192:195], v[72:75], v[104:107], v[192:195]
  v_mfma_f32_16x16x32_bf16 v[196:199], v[76:79], v[104:107], v[196:199]
  v_mfma_f32_16x16x32_bf16 v[200:203], v[80:83], v[104:107], v[200:203]
  v_mfma_f32_16x16x32_bf16 v[204:207], v[84:87], v[104:107], v[204:207]
  v_mfma_f32_16x16x32_bf16 v[208:211], v[72:75], v[108:111], v[208:211]
  v_mfma_f32_16x16x32_bf16 v[212:215], v[76:79], v[108:111], v[212:215]
  v_mfma_f32_16x16x32_bf16 v[216:219], v[80:83], v[108:111], v[216:219]
  v_mfma_f32_16x16x32_bf16 v[220:223], v[84:87], v[108:111], v[220:223]
  s_waitcnt lgkmcnt(0)
  v_mfma_f32_16x16x32_bf16 v[128:131], v[48:51], v[32:35], v[128:131]
  ds_read_b128 v[72:75], v19 offset:0
  v_mfma_f32_16x16x32_bf16 v[132:135], v[48:51], v[36:39], v[132:135]
  ds_read_b128 v[76:79], v19 offset:2048
  v_mfma_f32_16x16x32_bf16 v[136:139], v[48:51], v[40:43], v[136:139]
  ds_read_b128 v[80:83], v19 offset:4096
  v_mfma_f32_16x16x32_bf16 v[140:143], v[48:51], v[44:47], v[140:143]
  ds_read_b128 v[84:87], v19 offset:6144
  v_mfma_f32_16x16x32_bf16 v[144:147], v[52:55], v[32:35], v[144:147]
  ds_read_b64_tr_b16 v[88:89], v17 offset:12288
  v_mfma_f32_16x16x32_bf16 v[148:151], v[52:55], v[36:39], v[148:151]
  ds_read_b64_tr_b16 v[90:91], v17 offset:13824
  v_mfma_f32_16x16x32_bf16 v[152:155], v[52:55], v[40:43], v[152:155]
  ds_read_b64_tr_b16 v[92:93], v18 offset:12288
  v_mfma_f32_16x16x32_bf16 v[156:159], v[52:55], v[44:47], v[156:159]
  ds_read_b64_tr_b16 v[94:95], v18 offset:13824
  v_mfma_f32_16x16x32_bf16 v[160:163], v[56:59], v[32:35], v[160:163]
  ds_read_b64_tr_b16 v[96:97], v17 offset:12544
  v_mfma_f32_16x16x32_bf16 v[164:167], v[56:59], v[36:39], v[164:167]
  ds_read_b64_tr_b16 v[98:99], v17 offset:14080
  v_mfma_f32_16x16x32_bf16 v[168:171], v[56:59], v[40:43], v[168:171]
  ds_read_b64_tr_b16 v[100:101], v18 offset:12544
  v_mfma_f32_16x16x32_bf16 v[172:175], v[56:59], v[44:47], v[172:175]
  ds_read_b64_tr_b16 v[102:103], v18 offset:14080
  v_mfma_f32_16x16x32_bf16 v[176:179], v[60:63], v[32:35], v[176:179]
  ds_read_b64_tr_b16 v[104:105], v17 offset:12800
  v_mfma_f32_16x16x32_bf16 v[180:183], v[60:63], v[36:39], v[180:183]
  ds_read_b64_tr_b16 v[106:107], v17 offset:14336
  v_mfma_f32_16x16x32_bf16 v[184:187], v[60:63], v[40:43], v[184:187]
  ds_read_b64_tr_b16 v[108:109], v18 offset:12800
  v_mfma_f32_16x16x32_bf16 v[188:191], v[60:63], v[44:47], v[188:191]
  ds_read_b64_tr_b16 v[110:111], v18 offset:14336
  v_mfma_f32_16x16x32_bf16 v[192:195], v[32:35], v[64:67], v[192:195]
  v_add_u32 v12, s39, v8
  v_mfma_f32_16x16x32_bf16 v[196:199], v[36:39], v[64:67], v[196:199]
  v_add_u32 v13, s39, v9
  v_mfma_f32_16x16x32_bf16 v[200:203], v[40:43], v[64:67], v[200:203]
  v_add_u32 v14, s39, v10
  v_mfma_f32_16x16x32_bf16 v[204:207], v[44:47], v[64:67], v[204:207]
  v_add_u32 v15, s39, v11
  v_mfma_f32_16x16x32_bf16 v[208:211], v[32:35], v[68:71], v[208:211]
  s_add_u32 s39, s39, 40960
  v_mfma_f32_16x16x32_bf16 v[212:215], v[36:39], v[68:71], v[212:215]
  s_cmp_eq_u32 s39, 122880
  v_mfma_f32_16x16x32_bf16 v[216:219], v[40:43], v[68:71], v[216:219]
  s_cselect_b32 s39, 0, s39
  v_mfma_f32_16x16x32_bf16 v[220:223], v[44:47], v[68:71], v[220:223]
  s_sub_u32 s40, s40, 1
  s_cmp_lg_u32 s40, 0
  s_cbranch_scc1 qkv_cloop
  s_waitcnt lgkmcnt(0)
  s_barrier
  v_mfma_f32_16x16x32_bf16 v[128:131], v[88:91], v[72:75], v[128:131]
  v_mfma_f32_16x16x32_bf16 v[132:135], v[88:91], v[76:79], v[132:135]
  v_mfma_f32_16x16x32_bf16 v[136:139], v[88:91], v[80:83], v[136:139]
  v_mfma_f32_16x16x32_bf16 v[140:143], v[88:91], v[84:87], v[140:143]
  v_mfma_f32_16x16x32_bf16 v[144:147], v[92:95], v[72:75], v[144:147]
  v_mfma_f32_16x16x32_bf16 v[148:151], v[92:95], v[76:79], v[148:151]
  v_mfma_f32_16x16x32_bf16 v[152:155], v[92:95], v[80:83], v[152:155]
  v_mfma_f32_16x16x32_bf16 v[156:159], v[92:95], v[84:87], v[156:159]
  v_mfma_f32_16x16x32_bf16 v[160:163], v[96:99], v[72:75], v[160:163]
  v_mfma_f32_16x16x32_bf16 v[164:167], v[96:99], v[76:79], v[164:167]
  v_mfma_f32_16x16x32_bf16 v[168:171], v[96:99], v[80:83], v[168:171]
  v_mfma_f32_16x16x32_bf16 v[172:175], v[96:99], v[84:87], v[172:175]
  v_mfma_f32_16x16x32_bf16 v[176:179], v[100:103], v[72:75], v[176:179]
  v_mfma_f32_16x16x32_bf16 v[180:183], v[100:103], v[76:79], v[180:183]
  v_mfma_f32_16x16x32_bf16 v[184:187], v[100:103], v[80:83], v[184:187]
  v_mfma_f32_16x16x32_bf16 v[188:191], v[100:103], v[84:87], v[188:191]
  v_mfma_f32_16x16x32_bf16 v[192:195], v[72:75], v[104:107], v[192:195]
  v_mfma_f32_16x16x32_bf16 v[196:199], v[76:79], v[104:107], v[196:199]
  v_mfma_f32_16x16x32_bf16 v[200:203], v[80:83], v[104:107], v[200:203]
  v_mfma_f32_16x16x32_bf16 v[204:207], v[84:87], v[104:107], v[204:207]
  v_mfma_f32_16x16x32_bf16 v[208:211], v[72:75], v[108:111], v[208:211]
  v_mfma_f32_16x16x32_bf16 v[212:215], v[76:79], v[108:111], v[212:215]
  v_mfma_f32_16x16x32_bf16 v[216:219], v[80:83], v[108:111], v[216:219]
  v_mfma_f32_16x16x32_bf16 v[220:223], v[84:87], v[108:111], v[220:223]
  s_nop 7
  s_lshl_b32 s43, s38, 1
  s_and_b32 s44, s3, 1
  s_add_u32 s43, s43, s44
  s_lshl_b32 s43, s43, 6
  s_lshl_b32 s44, s37, 2
  s_add_u32 s43, s43, s44
  s_and_b32 s44, s3, 2
  s_add_u32 s43, s43, s44
  s_lshl_b32 s43, s43, 11
  v_lshrrev_b32 v1, 5, v0
  v_lshlrev_b32 v1, 10, v1
  v_bfe_u32 v2, v0, 4, 1
  v_lshl_add_u32 v1, v2, 9, v1
  v_add_u32 v1, s43, v1
  v_and_b32 v2, 15, v0
  v_lshl_add_u32 v16, v2, 4, v1
  v_bfe_u32 v3, v0, 3, 1
  v_and_b32 v2, 7, v0
  v_lshl_add_u32 v2, v3, 4, v2
  v_lshl_add_u32 v17, v2, 4, v1
  s_mov_b32 s44, 4194304
  s_mov_b32 s45, 8388608
  s_mov_b32 s46, 1048744942
  s_mov_b32 s47, 1048744942
  s_lshr_b32 s48, s3, 1
  s_lshl_b32 s48, s48, 9
  s_add_u32 s48, s48, 129280
  v_and_b32 v4, 15, v0
  v_lshl_add_u32 v5, v4, 3, s48
  v_lshrrev_b32 v6, 4, v0
  v_lshl_add_u32 v7, v6, 5, s48
  s_and_b32 s48, s3, 1
  s_mul_i32 s48, s48, 384
  s_add_u32 s48, s48, 130304
  v_lshl_add_u32 v6, v6, 4, s48
  v_lshl_add_u32 v4, v4, 2, s48
  ds_read_b64 v[18:19], v5 offset:0
  ds_read_b64 v[20:21], v5 offset:128
  ds_read_b64 v[22:23], v5 offset:256
  ds_read_b64 v[24:25], v5 offset:384
  ds_read_b128 v[32:35], v6 offset:0
  ds_read_b128 v[36:39], v6 offset:64
  ds_read_b128 v[40:43], v6 offset:128
  ds_read_b128 v[44:47], v6 offset:192
  ds_read_b128 v[48:51], v7 offset:0
  ds_read_b128 v[52:55], v7 offset:16
  ds_read_b128 v[56:59], v7 offset:128
  ds_read_b128 v[60:63], v7 offset:144
  ds_read_b128 v[64:67], v7 offset:256
  ds_read_b128 v[68:71], v7 offset:272
  ds_read_b128 v[72:75], v7 offset:384
  ds_read_b128 v[76:79], v7 offset:400
  ds_read_b32 v80, v4 offset:256
  ds_read_b32 v81, v4 offset:320
  s_waitcnt lgkmcnt(0)
  v_pk_mul_f32 v[26:27], v[40:41], v[18:19] op_sel:[0,1] op_sel_hi:[1,1]
  v_pk_fma_f32 v[160:161], v[160:161], v[18:19], v[26:27] op_sel_hi:[1,0,1]
  v_pk_mul_f32 v[26:27], v[42:43], v[18:19] op_sel:[0,1] op_sel_hi:[1,1]
  v_pk_fma_f32 v[162:163], v[162:163], v[18:19], v[26:27] op_sel_hi:[1,0,1]
  v_pk_mul_f32 v[26:27], v[44:45], v[18:19] op_sel:[0,1] op_sel_hi:[1,1]
  v_pk_fma_f32 v[176:177], v[176:177], v[18:19], v[26:27] op_sel_hi:[1,0,1]
  v_pk_mul_f32 v[26:27], v[46:47], v[18:19] op_sel:[0,1] op_sel_hi:[1,1]
  v_pk_fma_f32 v[178:179], v[178:179], v[18:19], v[26:27] op_sel_hi:[1,0,1]
  v_cvt_pk_bf16_f32 v84, v160, v161
  v_cvt_pk_bf16_f32 v85, v162, v163
  v_cvt_pk_bf16_f32 v86, v176, v177
  v_cvt_pk_bf16_f32 v87, v178, v179
  buffer_store_dwordx4 v[84:87], v17, s[16:19], s44 offen offset:0 sc1
  v_pk_mul_f32 v[26:27], v[40:41], v[20:21] op_sel:[0,1] op_sel_hi:[1,1]
  v_pk_fma_f32 v[164:165], v[164:165], v[20:21], v[26:27] op_sel_hi:[1,0,1]
  v_pk_mul_f32 v[26:27], v[42:43], v[20:21] op_sel:[0,1] op_sel_hi:[1,1]
  v_pk_fma_f32 v[166:167], v[166:167], v[20:21], v[26:27] op_sel_hi:[1,0,1]
  v_pk_mul_f32 v[26:27], v[44:45], v[20:21] op_sel:[0,1] op_sel_hi:[1,1]
  v_pk_fma_f32 v[180:181], v[180:181], v[20:21], v[26:27] op_sel_hi:[1,0,1]
  v_pk_mul_f32 v[26:27], v[46:47], v[20:21] op_sel:[0,1] op_sel_hi:[1,1]
  v_pk_fma_f32 v[182:183], v[182:183], v[20:21], v[26:27] op_sel_hi:[1,0,1]
  v_cvt_pk_bf16_f32 v88, v164, v165
  v_cvt_pk_bf16_f32 v89, v166, v167
  v_cvt_pk_bf16_f32 v90, v180, v181
  v_cvt_pk_bf16_f32 v91, v182, v183
  buffer_store_dwordx4 v[88:91], v17, s[16:19], s44 offen offset:128 sc1
  v_pk_mul_f32 v[26:27], v[40:41], v[22:23] op_sel:[0,1] op_sel_hi:[1,1]
  v_pk_fma_f32 v[168:169], v[168:169], v[22:23], v[26:27] op_sel_hi:[1,0,1]
  v_pk_mul_f32 v[26:27], v[42:43], v[22:23] op_sel:[0,1] op_sel_hi:[1,1]
  v_pk_fma_f32 v[170:171], v[170:171], v[22:23], v[26:27] op_sel_hi:[1,0,1]
  v_pk_mul_f32 v[26:27], v[44:45], v[22:23] op_sel:[0,1] op_sel_hi:[1,1]
  v_pk_fma_f32 v[184:185], v[184:185], v[22:23], v[26:27] op_sel_hi:[1,0,1]
  v_pk_mul_f32 v[26:27], v[46:47], v[22:23] op_sel:[0,1] op_sel_hi:[1,1]
  v_pk_fma_f32 v[186:187], v[186:187], v[22:23], v[26:27] op_sel_hi:[1,0,1]
  v_cvt_pk_bf16_f32 v92, v168, v169
  v_cvt_pk_bf16_f32 v93, v170, v171
  v_cvt_pk_bf16_f32 v94, v184, v185
  v_cvt_pk_bf16_f32 v95, v186, v187
  buffer_store_dwordx4 v[92:95], v17, s[16:19], s44 offen offset:2048 sc1
  v_pk_mul_f32 v[26:27], v[40:41], v[24:25] op_sel:[0,1] op_sel_hi:[1,1]
  v_pk_fma_f32 v[172:173], v[172:173], v[24:25], v[26:27] op_sel_hi:[1,0,1]
  v_pk_mul_f32 v[26:27], v[42:43], v[24:25] op_sel:[0,1] op_sel_hi:[1,1]
  v_pk_fma_f32 v[174:175], v[174:175], v[24:25], v[26:27] op_sel_hi:[1,0,1]
  v_pk_mul_f32 v[26:27], v[44:45], v[24:25] op_sel:[0,1] op_sel_hi:[1,1]
  v_pk_fma_f32 v[188:189], v[188:189], v[24:25], v[26:27] op_sel_hi:[1,0,1]
  v_pk_mul_f32 v[26:27], v[46:47], v[24:25] op_sel:[0,1] op_sel_hi:[1,1]
  v_pk_fma_f32 v[190:191], v[190:191], v[24:25], v[26:27] op_sel_hi:[1,0,1]
  v_cvt_pk_bf16_f32 v96, v172, v173
  v_cvt_pk_bf16_f32 v97, v174, v175
  v_cvt_pk_bf16_f32 v98, v188, v189
  v_cvt_pk_bf16_f32 v99, v190, v191
  buffer_store_dwordx4 v[96:99], v17, s[16:19], s44 offen offset:2176 sc1
  v_mul_f32 v26, v49, v80
  v_fma_f32 v192, v192, v48, v26
  v_mul_f32 v26, v51, v80
  v_fma_f32 v193, v193, v50, v26
  v_mul_f32 v26, v53, v80
  v_fma_f32 v194, v194, v52, v26
  v_mul_f32 v26, v55, v80
  v_fma_f32 v195, v195, v54, v26
  v_mul_f32 v26, v57, v80
  v_fma_f32 v196, v196, v56, v26
  v_mul_f32 v26, v59, v80
  v_fma_f32 v197, v197, v58, v26
  v_mul_f32 v26, v61, v80
  v_fma_f32 v198, v198, v60, v26
  v_mul_f32 v26, v63, v80
  v_fma_f32 v199, v199, v62, v26
  v_cvt_pk_bf16_f32 v100, v192, v193
  v_cvt_pk_bf16_f32 v101, v194, v195
  v_cvt_pk_bf16_f32 v102, v196, v197
  v_cvt_pk_bf16_f32 v103, v198, v199
  buffer_store_dwordx4 v[100:103], v16, s[16:19], s45 offen offset:0 sc1
  v_mul_f32 v26, v49, v81
  v_fma_f32 v208, v208, v48, v26
  v_mul_f32 v26, v51, v81
  v_fma_f32 v209, v209, v50, v26
  v_mul_f32 v26, v53, v81
  v_fma_f32 v210, v210, v52, v26
  v_mul_f32 v26, v55, v81
  v_fma_f32 v211, v211, v54, v26
  v_mul_f32 v26, v57, v81
  v_fma_f32 v212, v212, v56, v26
  v_mul_f32 v26, v59, v81
  v_fma_f32 v213, v213, v58, v26
  v_mul_f32 v26, v61, v81
  v_fma_f32 v214, v214, v60, v26
  v_mul_f32 v26, v63, v81
  v_fma_f32 v215, v215, v62, v26
  v_cvt_pk_bf16_f32 v104, v208, v209
  v_cvt_pk_bf16_f32 v105, v210, v211
  v_cvt_pk_bf16_f32 v106, v212, v213
  v_cvt_pk_bf16_f32 v107, v214, v215
  buffer_store_dwordx4 v[104:107], v16, s[16:19], s45 offen offset:256 sc1
  v_mul_f32 v26, v65, v80
  v_fma_f32 v200, v200, v64, v26
  v_mul_f32 v26, v67, v80
  v_fma_f32 v201, v201, v66, v26
  v_mul_f32 v26, v69, v80
  v_fma_f32 v202, v202, v68, v26
  v_mul_f32 v26, v71, v80
  v_fma_f32 v203, v203, v70, v26
  v_mul_f32 v26, v73, v80
  v_fma_f32 v204, v204, v72, v26
  v_mul_f32 v26, v75, v80
  v_fma_f32 v205, v205, v74, v26
  v_mul_f32 v26, v77, v80
  v_fma_f32 v206, v206, v76, v26
  v_mul_f32 v26, v79, v80
  v_fma_f32 v207, v207, v78, v26
  v_cvt_pk_bf16_f32 v108, v200, v201
  v_cvt_pk_bf16_f32 v109, v202, v203
  v_cvt_pk_bf16_f32 v110, v204, v205
  v_cvt_pk_bf16_f32 v111, v206, v207
  buffer_store_dwordx4 v[108:111], v16, s[16:19], s45 offen offset:2048 sc1
  v_mul_f32 v26, v65, v81
  v_fma_f32 v216, v216, v64, v26
  v_mul_f32 v26, v67, v81
  v_fma_f32 v217, v217, v66, v26
  v_mul_f32 v26, v69, v81
  v_fma_f32 v218, v218, v68, v26
  v_mul_f32 v26, v71, v81
  v_fma_f32 v219, v219, v70, v26
  v_mul_f32 v26, v73, v81
  v_fma_f32 v220, v220, v72, v26
  v_mul_f32 v26, v75, v81
  v_fma_f32 v221, v221, v74, v26
  v_mul_f32 v26, v77, v81
  v_fma_f32 v222, v222, v76, v26
  v_mul_f32 v26, v79, v81
  v_fma_f32 v223, v223, v78, v26
  v_cvt_pk_bf16_f32 v112, v216, v217
  v_cvt_pk_bf16_f32 v113, v218, v219
  v_cvt_pk_bf16_f32 v114, v220, v221
  v_cvt_pk_bf16_f32 v115, v222, v223
  buffer_store_dwordx4 v[112:115], v16, s[16:19], s45 offen offset:2304 sc1
  v_pk_mul_f32 v[26:27], v[32:33], v[18:19] op_sel:[0,1] op_sel_hi:[1,1]
  v_pk_fma_f32 v[128:129], v[128:129], v[18:19], v[26:27] op_sel_hi:[1,0,1]
  v_pk_mul_f32 v[26:27], v[34:35], v[18:19] op_sel:[0,1] op_sel_hi:[1,1]
  v_pk_fma_f32 v[130:131], v[130:131], v[18:19], v[26:27] op_sel_hi:[1,0,1]
  v_pk_mul_f32 v[128:129], v[128:129], s[46:47]
  v_pk_mul_f32 v[130:131], v[130:131], s[46:47]
  v_pk_mul_f32 v[26:27], v[36:37], v[18:19] op_sel:[0,1] op_sel_hi:[1,1]
  v_pk_fma_f32 v[144:145], v[144:145], v[18:19], v[26:27] op_sel_hi:[1,0,1]
  v_pk_mul_f32 v[26:27], v[38:39], v[18:19] op_sel:[0,1] op_sel_hi:[1,1]
  v_pk_fma_f32 v[146:147], v[146:147], v[18:19], v[26:27] op_sel_hi:[1,0,1]
  v_pk_mul_f32 v[144:145], v[144:145], s[46:47]
  v_pk_mul_f32 v[146:147], v[146:147], s[46:47]
  v_cvt_pk_bf16_f32 v116, v128, v129
  v_cvt_pk_bf16_f32 v117, v130, v131
  v_cvt_pk_bf16_f32 v118, v144, v145
  v_cvt_pk_bf16_f32 v119, v146, v147
  buffer_store_dwordx4 v[116:119], v16, s[16:19], 0 offen offset:0 sc1
  v_pk_mul_f32 v[26:27], v[32:33], v[20:21] op_sel:[0,1] op_sel_hi:[1,1]
  v_pk_fma_f32 v[132:133], v[132:133], v[20:21], v[26:27] op_sel_hi:[1,0,1]
  v_pk_mul_f32 v[26:27], v[34:35], v[20:21] op_sel:[0,1] op_sel_hi:[1,1]
  v_pk_fma_f32 v[134:135], v[134:135], v[20:21], v[26:27] op_sel_hi:[1,0,1]
  v_pk_mul_f32 v[132:133], v[132:133], s[46:47]
  v_pk_mul_f32 v[134:135], v[134:135], s[46:47]
  v_pk_mul_f32 v[26:27], v[36:37], v[20:21] op_sel:[0,1] op_sel_hi:[1,1]
  v_pk_fma_f32 v[148:149], v[148:149], v[20:21], v[26:27] op_sel_hi:[1,0,1]
  v_pk_mul_f32 v[26:27], v[38:39], v[20:21] op_sel:[0,1] op_sel_hi:[1,1]
  v_pk_fma_f32 v[150:151], v[150:151], v[20:21], v[26:27] op_sel_hi:[1,0,1]
  v_pk_mul_f32 v[148:149], v[148:149], s[46:47]
  v_pk_mul_f32 v[150:151], v[150:151], s[46:47]
  v_cvt_pk_bf16_f32 v120, v132, v133
  v_cvt_pk_bf16_f32 v121, v134, v135
  v_cvt_pk_bf16_f32 v122, v148, v149
  v_cvt_pk_bf16_f32 v123, v150, v151
  buffer_store_dwordx4 v[120:123], v16, s[16:19], 0 offen offset:256 sc1
  v_pk_mul_f32 v[26:27], v[32:33], v[22:23] op_sel:[0,1] op_sel_hi:[1,1]
  v_pk_fma_f32 v[136:137], v[136:137], v[22:23], v[26:27] op_sel_hi:[1,0,1]
  v_pk_mul_f32 v[26:27], v[34:35], v[22:23] op_sel:[0,1] op_sel_hi:[1,1]
  v_pk_fma_f32 v[138:139], v[138:139], v[22:23], v[26:27] op_sel_hi:[1,0,1]
  v_pk_mul_f32 v[136:137], v[136:137], s[46:47]
  v_pk_mul_f32 v[138:139], v[138:139], s[46:47]
  v_pk_mul_f32 v[26:27], v[36:37], v[22:23] op_sel:[0,1] op_sel_hi:[1,1]
  v_pk_fma_f32 v[152:153], v[152:153], v[22:23], v[26:27] op_sel_hi:[1,0,1]
  v_pk_mul_f32 v[26:27], v[38:39], v[22:23] op_sel:[0,1] op_sel_hi:[1,1]
  v_pk_fma_f32 v[154:155], v[154:155], v[22:23], v[26:27] op_sel_hi:[1,0,1]
  v_pk_mul_f32 v[152:153], v[152:153], s[46:47]
  v_pk_mul_f32 v[154:155], v[154:155], s[46:47]
  v_cvt_pk_bf16_f32 v84, v136, v137
  v_cvt_pk_bf16_f32 v85, v138, v139
  v_cvt_pk_bf16_f32 v86, v152, v153
  v_cvt_pk_bf16_f32 v87, v154, v155
  buffer_store_dwordx4 v[84:87], v16, s[16:19], 0 offen offset:2048 sc1
  v_pk_mul_f32 v[26:27], v[32:33], v[24:25] op_sel:[0,1] op_sel_hi:[1,1]
  v_pk_fma_f32 v[140:141], v[140:141], v[24:25], v[26:27] op_sel_hi:[1,0,1]
  v_pk_mul_f32 v[26:27], v[34:35], v[24:25] op_sel:[0,1] op_sel_hi:[1,1]
  v_pk_fma_f32 v[142:143], v[142:143], v[24:25], v[26:27] op_sel_hi:[1,0,1]
  v_pk_mul_f32 v[140:141], v[140:141], s[46:47]
  v_pk_mul_f32 v[142:143], v[142:143], s[46:47]
  v_pk_mul_f32 v[26:27], v[36:37], v[24:25] op_sel:[0,1] op_sel_hi:[1,1]
  v_pk_fma_f32 v[156:157], v[156:157], v[24:25], v[26:27] op_sel_hi:[1,0,1]
  v_pk_mul_f32 v[26:27], v[38:39], v[24:25] op_sel:[0,1] op_sel_hi:[1,1]
  v_pk_fma_f32 v[158:159], v[158:159], v[24:25], v[26:27] op_sel_hi:[1,0,1]
  v_pk_mul_f32 v[156:157], v[156:157], s[46:47]
  v_pk_mul_f32 v[158:159], v[158:159], s[46:47]
  v_cvt_pk_bf16_f32 v88, v140, v141
  v_cvt_pk_bf16_f32 v89, v142, v143
  v_cvt_pk_bf16_f32 v90, v156, v157
  v_cvt_pk_bf16_f32 v91, v158, v159
  buffer_store_dwordx4 v[88:91], v16, s[16:19], 0 offen offset:2304 sc1
  s_waitcnt vmcnt(0)
  s_barrier
C_att:
  s_load_dwordx2 s[8:9], s[0:1], 80
  s_load_dwordx2 s[12:13], s[0:1], 80
  s_and_b32 s43, s2, 7
  s_lshr_b32 s44, s2, 3
  s_lshl_b32 s37, s43, 2
  s_lshr_b32 s45, s44, 3
  s_add_u32 s37, s37, s45
  s_and_b32 s38, s44, 7
  s_and_b32 s46, s3, 3
  s_lshr_b32 s47, s3, 2
  s_lshl_b32 s43, s37, 17
  s_add_u32 s50, s43, 4194304
  s_lshl_b32 s44, s47, 16
  s_add_u32 s41, s50, s44
  s_add_u32 s42, s41, 4194304
  v_lshlrev_b32 v1, 4, v0
  s_lshl_b32 s43, s37, 6
  s_lshl_b32 s44, s38, 3
  s_add_u32 s43, s43, s44
  s_lshl_b32 s44, s46, 1
  s_add_u32 s43, s43, s44
  s_lshl_b32 s48, s43, 11
  s_add_u32 s49, s48, 2048
  v_and_b32 v2, 3, v0
  v_bfe_u32 v3, v0, 2, 1
  v_bfe_u32 v4, v0, 4, 1
  v_xor_b32 v3, v3, v4
  v_or_b32 v2, v2, v3
  v_cmp_eq_u32 vcc, 0, v2
  v_mov_b32 v3, 0x3f803f80
  s_nop 0
  v_cndmask_b32 v4, 0, v3, vcc
  v_mov_b32 v5, v4
  v_mov_b32 v6, v4
  v_mov_b32 v7, v4
  v_mov_b32 v24, 0
  v_mov_b32 v25, 0
  v_mov_b32 v26, 0
  v_mov_b32 v27, 0
  v_mov_b32 v32, 0
  v_mov_b32 v33, 0
  v_mov_b32 v34, 0
  v_mov_b32 v35, 0
  v_mov_b32 v36, 0
  v_mov_b32 v37, 0
  v_mov_b32 v38, 0
  v_mov_b32 v39, 0
  v_mov_b32 v40, 0
  v_mov_b32 v41, 0
  v_mov_b32 v42, 0
  v_mov_b32 v43, 0
  v_mov_b32 v44, 0
  v_mov_b32 v45, 0
  v_mov_b32 v46, 0
  v_mov_b32 v47, 0
  v_mov_b32 v164, 0
  v_mov_b32 v165, 0
  v_mov_b32 v166, 0
  v_mov_b32 v167, 0
  v_mov_b32 v28, 0
  v_mov_b32 v29, 0
  v_mov_b32 v30, 0
  v_mov_b32 v31, 0
  v_mov_b32 v48, 0
  v_mov_b32 v49, 0
  v_mov_b32 v50, 0
  v_mov_b32 v51, 0
  v_mov_b32 v52, 0
  v_mov_b32 v53, 0
  v_mov_b32 v54, 0
  v_mov_b32 v55, 0
  v_mov_b32 v56, 0
  v_mov_b32 v57, 0
  v_mov_b32 v58, 0
  v_mov_b32 v59, 0
  v_mov_b32 v60, 0
  v_mov_b32 v61, 0
  v_mov_b32 v62, 0
  v_mov_b32 v63, 0
  v_mov_b32 v172, 0
  v_mov_b32 v173, 0
  v_mov_b32 v174, 0
  v_mov_b32 v175, 0
  s_waitcnt lgkmcnt(0)
  s_add_u32 s8, s8, 4194304
  s_addc_u32 s9, s9, 0
  s_mov_b32 s10, 12582912
  s_mov_b32 s11, 0x00020000
  s_add_u32 s12, s12, 16777216
  s_addc_u32 s13, s13, 0
  s_mov_b32 s14, 4194304
  s_mov_b32 s15, 0x00020000
  s_mov_b32 s36, s3
  s_load_dwordx2 s[20:21], s[0:1], 16
  s_load_dwordx2 s[22:23], s[0:1], 48
  s_load_dwordx2 s[24:25], s[0:1], 32
  s_waitcnt lgkmcnt(0)
  s_sub_u32 s43, 7, s36
  s_lshl_b32 s43, s43, 8
  s_add_u32 s43, s43, s2
  v_lshlrev_b32 v240, 7, v0
  s_mov_b32 s19, 0x00020000
  s_cmp_lt_u32 s43, 256
  s_cbranch_scc0 att_pf1
  s_mov_b32 s16, s20
  s_mov_b32 s17, s21
  s_mov_b32 s18, 2097152
  s_branch att_pf3
att_pf1:
  s_sub_u32 s43, s43, 256
  s_cmp_lt_u32 s43, 896
  s_cbranch_scc0 att_pf2
  s_mov_b32 s16, s24
  s_mov_b32 s17, s25
  s_mov_b32 s18, 7340032
  s_branch att_pf3
att_pf2:
  s_sub_u32 s43, s43, 896
  s_mov_b32 s16, s22
  s_mov_b32 s17, s23
  s_mov_b32 s18, 7340032
att_pf3:
  s_lshl_b32 s51, s43, 13
  s_branch att_dep
C_wo:
  s_waitcnt vmcnt(0)
  s_barrier
  s_load_dwordx2 s[20:21], s[0:1], 32
  s_load_dwordx2 s[24:25], s[0:1], 80
  s_waitcnt lgkmcnt(0)
  s_mov_b32 s22, 7340032
  s_mov_b32 s23, 0x00020000
  s_add_u32 s24, s24, 42991616
  s_addc_u32 s25, s25, 0
  s_mov_b32 s26, 229376
  s_mov_b32 s27, 0x00020000
  s_mov_b32 s43, s3
  s_lshr_b32 s44, s2, 4
  s_lshl_b32 s44, s44, 6
  v_lshrrev_b32 v48, 3, v0
  v_add_u32 v48, s44, v48
  s_mov_b32 s45, 7168
  v_mul_lo_u32 v48, v48, s45
  v_and_b32 v49, 7, v0
  v_min_u32 v49, 6, v49
  s_mul_i32 s44, s43, 7
  v_add_u32 v49, s44, v49
  s_and_b32 s44, s2, 15
  s_mul_i32 s45, s44, 448
  v_lshl_add_u32 v50, v49, 4, s45
  v_add_u32 v48, v48, v50
  s_mov_b32 s45, 0
  buffer_load_dwordx4 v[64:67], v48, s[20:23], s45 offen
  s_add_u32 s45, s45, 57344
  buffer_load_dwordx4 v[68:71], v48, s[20:23], s45 offen
  s_add_u32 s45, s45, 57344
  buffer_load_dwordx4 v[72:75], v48, s[20:23], s45 offen
  s_add_u32 s45, s45, 57344
  buffer_load_dwordx4 v[76:79], v48, s[20:23], s45 offen
  s_add_u32 s45, s45, 57344
  buffer_load_dwordx4 v[80:83], v48, s[20:23], s45 offen
  s_add_u32 s45, s45, 57344
  buffer_load_dwordx4 v[84:87], v48, s[20:23], s45 offen
  s_add_u32 s45, s45, 57344
  buffer_load_dwordx4 v[88:91], v48, s[20:23], s45 offen
  s_add_u32 s45, s45, 57344
  buffer_load_dwordx4 v[92:95], v48, s[20:23], s45 offen
  s_add_u32 s45, s45, 57344
  s_waitcnt vmcnt(0)
  v_lshlrev_b32 v96, 16, v64
  v_and_b32 v97, 0xffff0000, v64
  v_lshlrev_b32 v98, 16, v65
  v_and_b32 v99, 0xffff0000, v65
  v_lshlrev_b32 v100, 16, v66
  v_and_b32 v101, 0xffff0000, v66
  v_lshlrev_b32 v102, 16, v67
  v_and_b32 v103, 0xffff0000, v67
  v_lshlrev_b32 v104, 16, v68
  v_and_b32 v105, 0xffff0000, v68
  v_pk_add_f32 v[96:97], v[96:97], v[104:105]
  v_lshlrev_b32 v104, 16, v69
  v_and_b32 v105, 0xffff0000, v69
  v_pk_add_f32 v[98:99], v[98:99], v[104:105]
  v_lshlrev_b32 v104, 16, v70
  v_and_b32 v105, 0xffff0000, v70
  v_pk_add_f32 v[100:101], v[100:101], v[104:105]
  v_lshlrev_b32 v104, 16, v71
  v_and_b32 v105, 0xffff0000, v71
  v_pk_add_f32 v[102:103], v[102:103], v[104:105]
  v_lshlrev_b32 v104, 16, v72
  v_and_b32 v105, 0xffff0000, v72
  v_pk_add_f32 v[96:97], v[96:97], v[104:105]
  v_lshlrev_b32 v104, 16, v73
  v_and_b32 v105, 0xffff0000, v73
  v_pk_add_f32 v[98:99], v[98:99], v[104:105]
  v_lshlrev_b32 v104, 16, v74
  v_and_b32 v105, 0xffff0000, v74
  v_pk_add_f32 v[100:101], v[100:101], v[104:105]
  v_lshlrev_b32 v104, 16, v75
  v_and_b32 v105, 0xffff0000, v75
  v_pk_add_f32 v[102:103], v[102:103], v[104:105]
  v_lshlrev_b32 v104, 16, v76
  v_and_b32 v105, 0xffff0000, v76
  v_pk_add_f32 v[96:97], v[96:97], v[104:105]
  v_lshlrev_b32 v104, 16, v77
  v_and_b32 v105, 0xffff0000, v77
  v_pk_add_f32 v[98:99], v[98:99], v[104:105]
  v_lshlrev_b32 v104, 16, v78
  v_and_b32 v105, 0xffff0000, v78
  v_pk_add_f32 v[100:101], v[100:101], v[104:105]
  v_lshlrev_b32 v104, 16, v79
  v_and_b32 v105, 0xffff0000, v79
  v_pk_add_f32 v[102:103], v[102:103], v[104:105]
  v_lshlrev_b32 v104, 16, v80
  v_and_b32 v105, 0xffff0000, v80
  v_pk_add_f32 v[96:97], v[96:97], v[104:105]
  v_lshlrev_b32 v104, 16, v81
  v_and_b32 v105, 0xffff0000, v81
  v_pk_add_f32 v[98:99], v[98:99], v[104:105]
  v_lshlrev_b32 v104, 16, v82
  v_and_b32 v105, 0xffff0000, v82
  v_pk_add_f32 v[100:101], v[100:101], v[104:105]
  v_lshlrev_b32 v104, 16, v83
  v_and_b32 v105, 0xffff0000, v83
  v_pk_add_f32 v[102:103], v[102:103], v[104:105]
  v_lshlrev_b32 v104, 16, v84
  v_and_b32 v105, 0xffff0000, v84
  v_pk_add_f32 v[96:97], v[96:97], v[104:105]
  v_lshlrev_b32 v104, 16, v85
  v_and_b32 v105, 0xffff0000, v85
  v_pk_add_f32 v[98:99], v[98:99], v[104:105]
  v_lshlrev_b32 v104, 16, v86
  v_and_b32 v105, 0xffff0000, v86
  v_pk_add_f32 v[100:101], v[100:101], v[104:105]
  v_lshlrev_b32 v104, 16, v87
  v_and_b32 v105, 0xffff0000, v87
  v_pk_add_f32 v[102:103], v[102:103], v[104:105]
  v_lshlrev_b32 v104, 16, v88
  v_and_b32 v105, 0xffff0000, v88
  v_pk_add_f32 v[96:97], v[96:97], v[104:105]
  v_lshlrev_b32 v104, 16, v89
  v_and_b32 v105, 0xffff0000, v89
  v_pk_add_f32 v[98:99], v[98:99], v[104:105]
  v_lshlrev_b32 v104, 16, v90
  v_and_b32 v105, 0xffff0000, v90
  v_pk_add_f32 v[100:101], v[100:101], v[104:105]
  v_lshlrev_b32 v104, 16, v91
  v_and_b32 v105, 0xffff0000, v91
  v_pk_add_f32 v[102:103], v[102:103], v[104:105]
  v_lshlrev_b32 v104, 16, v92
  v_and_b32 v105, 0xffff0000, v92
  v_pk_add_f32 v[96:97], v[96:97], v[104:105]
  v_lshlrev_b32 v104, 16, v93
  v_and_b32 v105, 0xffff0000, v93
  v_pk_add_f32 v[98:99], v[98:99], v[104:105]
  v_lshlrev_b32 v104, 16, v94
  v_and_b32 v105, 0xffff0000, v94
  v_pk_add_f32 v[100:101], v[100:101], v[104:105]
  v_lshlrev_b32 v104, 16, v95
  v_and_b32 v105, 0xffff0000, v95
  v_pk_add_f32 v[102:103], v[102:103], v[104:105]
  s_nop 1
  v_add_f32_dpp v96, v96, v96 row_ror:8 row_mask:0xf bank_mask:0xf
  v_add_f32_dpp v97, v97, v97 row_ror:8 row_mask:0xf bank_mask:0xf
  v_add_f32_dpp v98, v98, v98 row_ror:8 row_mask:0xf bank_mask:0xf
  v_add_f32_dpp v99, v99, v99 row_ror:8 row_mask:0xf bank_mask:0xf
  v_add_f32_dpp v100, v100, v100 row_ror:8 row_mask:0xf bank_mask:0xf
  v_add_f32_dpp v101, v101, v101 row_ror:8 row_mask:0xf bank_mask:0xf
  v_add_f32_dpp v102, v102, v102 row_ror:8 row_mask:0xf bank_mask:0xf
  v_add_f32_dpp v103, v103, v103 row_ror:8 row_mask:0xf bank_mask:0xf
  v_mov_b32 v104, v96
  v_mov_b32 v105, v97
  v_mov_b32 v106, v98
  v_mov_b32 v107, v99
  v_mov_b32 v108, v100
  v_mov_b32 v109, v101
  v_mov_b32 v110, v102
  v_mov_b32 v111, v103
  s_nop 1
  v_permlane16_swap_b32 v104, v96
  v_permlane16_swap_b32 v105, v97
  v_permlane16_swap_b32 v106, v98
  v_permlane16_swap_b32 v107, v99
  v_permlane16_swap_b32 v108, v100
  v_permlane16_swap_b32 v109, v101
  v_permlane16_swap_b32 v110, v102
  v_permlane16_swap_b32 v111, v103
  s_nop 1
  v_add_f32 v96, v96, v104
  v_add_f32 v97, v97, v105
  v_add_f32 v98, v98, v106
  v_add_f32 v99, v99, v107
  v_add_f32 v100, v100, v108
  v_add_f32 v101, v101, v109
  v_add_f32 v102, v102, v110
  v_add_f32 v103, v103, v111
  v_mov_b32 v104, v96
  v_mov_b32 v105, v97
  v_mov_b32 v106, v98
  v_mov_b32 v107, v99
  v_mov_b32 v108, v100
  v_mov_b32 v109, v101
  v_mov_b32 v110, v102
  v_mov_b32 v111, v103
  s_nop 1
  v_permlane32_swap_b32 v104, v96
  v_permlane32_swap_b32 v105, v97
  v_permlane32_swap_b32 v106, v98
  v_permlane32_swap_b32 v107, v99
  v_permlane32_swap_b32 v108, v100
  v_permlane32_swap_b32 v109, v101
  v_permlane32_swap_b32 v110, v102
  v_permlane32_swap_b32 v111, v103
  s_nop 1
  v_add_f32 v96, v96, v104
  v_add_f32 v97, v97, v105
  v_add_f32 v98, v98, v106
  v_add_f32 v99, v99, v107
  v_add_f32 v100, v100, v108
  v_add_f32 v101, v101, v109
  v_add_f32 v102, v102, v110
  v_add_f32 v103, v103, v111
  s_lshr_b32 s44, s2, 4
  s_mul_i32 s44, s44, 14336
  s_and_b32 s45, s2, 15
  s_mul_i32 s45, s45, 896
  s_add_u32 s44, s44, s45
  v_lshl_add_u32 v50, v49, 5, s44
  s_mov_b64 s[50:51], exec
  s_mov_b64 exec, 0x7f
  buffer_store_dwordx4 v[96:99], v50, s[24:27], 0 offen sc1
  buffer_store_dwordx4 v[100:103], v50, s[24:27], 0 offen offset:16 sc1
  s_mov_b64 exec, s[50:51]
C_wo2:
  s_load_dwordx2 s[8:9], s[0:1], 80
  s_load_dwordx2 s[16:17], s[0:1], 80
  s_load_dwordx2 s[24:25], s[0:1], 80
  s_and_b32 s43, s2, 7
  s_lshr_b32 s44, s2, 3
  s_and_b32 s37, s43, 3
  s_mul_i32 s37, s37, 4
  s_and_b32 s45, s44, 3
  s_add_u32 s37, s37, s45
  s_lshr_b32 s38, s43, 2
  s_mul_i32 s38, s38, 8
  s_lshr_b32 s45, s44, 2
  s_add_u32 s38, s38, s45
  s_lshl_b32 s43, s37, 3
  s_lshl_b32 s44, s3, 1
  s_add_u32 s43, s43, s44
  s_lshl_b32 s43, s43, 15
  v_lshl_add_u32 v8, v0, 4, s43
  v_add_u32 v9, 32768, v8
  v_lshrrev_b32 v1, 4, v0
  v_lshrrev_b32 v2, 1, v1
  v_and_b32 v3, 1, v1
  v_lshl_add_u32 v2, v2, 2, v3
  v_lshlrev_b32 v10, 9, v2
  v_bfe_u32 v1, v0, 2, 2
  v_lshl_add_u32 v10, v1, 6, v10
  v_and_b32 v1, 3, v0
  v_lshl_add_u32 v10, v1, 3, v10
  v_lshlrev_b32 v3, 5, v3
  v_xor_b32 v2, 32, v3
  v_add_u32 v11, v10, v2
  v_add_u32 v10, v10, v3
  v_mov_b32 v32, 0
  v_mov_b32 v33, 0
  v_mov_b32 v34, 0
  v_mov_b32 v35, 0
  s_nop 1
  v_mfma_f32_32x32x16_bf16 v[128:143], v[32:35], v[32:35], 0
  v_mfma_f32_32x32x16_bf16 v[144:159], v[32:35], v[32:35], 0
  s_waitcnt lgkmcnt(0)
  s_add_u32 s8, s8, 16777216
  s_addc_u32 s9, s9, 0
  s_mov_b32 s10, 4194304
  s_mov_b32 s11, 0x00020000
  s_add_u32 s16, s16, 20971520
  s_addc_u32 s17, s17, 0
  s_mov_b32 s18, 4194304
  s_mov_b32 s19, 0x00020000
  s_add_u32 s24, s24, 41943040
  s_addc_u32 s25, s25, 0
  s_mov_b32 s26, 262144
  s_mov_b32 s27, 0x00020000
  s_barrier
  s_mov_b32 s41, 0
  s_mov_b32 s42, 4096
  buffer_load_dwordx4 v[32:35], v8, s[8:11], s41 offen offset:0
  buffer_load_dwordx4 v[36:39], v9, s[8:11], s41 offen offset:0
  buffer_load_dwordx4 v[40:43], v8, s[8:11], s41 offen offset:1024
  buffer_load_dwordx4 v[44:47], v9, s[8:11], s41 offen offset:1024
  buffer_load_dwordx4 v[48:51], v8, s[8:11], s41 offen offset:2048
  buffer_load_dwordx4 v[52:55], v9, s[8:11], s41 offen offset:2048
  buffer_load_dwordx4 v[56:59], v8, s[8:11], s41 offen offset:3072
  buffer_load_dwordx4 v[60:63], v9, s[8:11], s41 offen offset:3072
  buffer_load_dwordx4 v[64:67], v8, s[8:11], s42 offen offset:0
  buffer_load_dwordx4 v[68:71], v9, s[8:11], s42 offen offset:0
  buffer_load_dwordx4 v[72:75], v8, s[8:11], s42 offen offset:1024
  buffer_load_dwordx4 v[76:79], v9, s[8:11], s42 offen offset:1024
  buffer_load_dwordx4 v[80:83], v8, s[8:11], s42 offen offset:2048
  buffer_load_dwordx4 v[84:87], v9, s[8:11], s42 offen offset:2048
  buffer_load_dwordx4 v[88:91], v8, s[8:11], s42 offen offset:3072
  buffer_load_dwordx4 v[92:95], v9, s[8:11], s42 offen offset:3072
  v_add_u32 v12, 65536, v10
  v_add_u32 v13, 65536, v11
  ds_read_b64_tr_b16 v[96:97], v10 offset:0
  ds_read_b64_tr_b16 v[98:99], v10 offset:1024
  ds_read_b64_tr_b16 v[100:101], v11 offset:0
  ds_read_b64_tr_b16 v[102:103], v11 offset:1024
  ds_read_b64_tr_b16 v[104:105], v10 offset:256
  ds_read_b64_tr_b16 v[106:107], v10 offset:1280
  ds_read_b64_tr_b16 v[108:109], v11 offset:256
  ds_read_b64_tr_b16 v[110:111], v11 offset:1280
  s_mov_b32 s41, 8192
  s_mov_b32 s42, 12288
  s_mov_b32 s40, 4
.p2align 6
wo_cloop:
  s_cmp_eq_u32 s40, 1
  s_cselect_b32 s10, 0, 4194304
  s_waitcnt vmcnt(14) lgkmcnt(0)
  v_mfma_f32_16x16x32_bf16 v[128:131], v[96:99], v[32:35], v[128:131]
  ds_read_b64_tr_b16 v[112:113], v10 offset:4096
  v_mfma_f32_16x16x32_bf16 v[132:135], v[96:99], v[36:39], v[132:135]
  ds_read_b64_tr_b16 v[114:115], v10 offset:5120
  v_mfma_f32_16x16x32_bf16 v[136:139], v[100:103], v[32:35], v[136:139]
  ds_read_b64_tr_b16 v[116:117], v11 offset:4096
  v_mfma_f32_16x16x32_bf16 v[140:143], v[100:103], v[36:39], v[140:143]
  ds_read_b64_tr_b16 v[118:119], v11 offset:5120
  v_mfma_f32_16x16x32_bf16 v[144:147], v[104:107], v[32:35], v[144:147]
  ds_read_b64_tr_b16 v[120:121], v10 offset:4352
  v_mfma_f32_16x16x32_bf16 v[148:151], v[104:107], v[36:39], v[148:151]
  ds_read_b64_tr_b16 v[122:123], v10 offset:5376
  v_mfma_f32_16x16x32_bf16 v[152:155], v[108:111], v[32:35], v[152:155]
  ds_read_b64_tr_b16 v[124:125], v11 offset:4352
  v_mfma_f32_16x16x32_bf16 v[156:159], v[108:111], v[36:39], v[156:159]
  ds_read_b64_tr_b16 v[126:127], v11 offset:5376
  buffer_load_dwordx4 v[32:35], v8, s[8:11], s41 offen offset:0
  buffer_load_dwordx4 v[36:39], v9, s[8:11], s41 offen offset:0
  s_waitcnt vmcnt(14) lgkmcnt(0)
  v_mfma_f32_16x16x32_bf16 v[128:131], v[112:115], v[40:43], v[128:131]
  ds_read_b64_tr_b16 v[96:97], v10 offset:8192
  v_mfma_f32_16x16x32_bf16 v[132:135], v[112:115], v[44:47], v[132:135]
  ds_read_b64_tr_b16 v[98:99], v10 offset:9216
  v_mfma_f32_16x16x32_bf16 v[136:139], v[116:119], v[40:43], v[136:139]
  ds_read_b64_tr_b16 v[100:101], v11 offset:8192
  v_mfma_f32_16x16x32_bf16 v[140:143], v[116:119], v[44:47], v[140:143]
  ds_read_b64_tr_b16 v[102:103], v11 offset:9216
  v_mfma_f32_16x16x32_bf16 v[144:147], v[120:123], v[40:43], v[144:147]
  ds_read_b64_tr_b16 v[104:105], v10 offset:8448
  v_mfma_f32_16x16x32_bf16 v[148:151], v[120:123], v[44:47], v[148:151]
  ds_read_b64_tr_b16 v[106:107], v10 offset:9472
  v_mfma_f32_16x16x32_bf16 v[152:155], v[124:127], v[40:43], v[152:155]
  ds_read_b64_tr_b16 v[108:109], v11 offset:8448
  v_mfma_f32_16x16x32_bf16 v[156:159], v[124:127], v[44:47], v[156:159]
  ds_read_b64_tr_b16 v[110:111], v11 offset:9472
  buffer_load_dwordx4 v[40:43], v8, s[8:11], s41 offen offset:1024
  buffer_load_dwordx4 v[44:47], v9, s[8:11], s41 offen offset:1024
  s_waitcnt vmcnt(14) lgkmcnt(0)
  v_mfma_f32_16x16x32_bf16 v[128:131], v[96:99], v[48:51], v[128:131]
  ds_read_b64_tr_b16 v[112:113], v10 offset:12288
  v_mfma_f32_16x16x32_bf16 v[132:135], v[96:99], v[52:55], v[132:135]
  ds_read_b64_tr_b16 v[114:115], v10 offset:13312
  v_mfma_f32_16x16x32_bf16 v[136:139], v[100:103], v[48:51], v[136:139]
  ds_read_b64_tr_b16 v[116:117], v11 offset:12288
  v_mfma_f32_16x16x32_bf16 v[140:143], v[100:103], v[52:55], v[140:143]
  ds_read_b64_tr_b16 v[118:119], v11 offset:13312
  v_mfma_f32_16x16x32_bf16 v[144:147], v[104:107], v[48:51], v[144:147]
  ds_read_b64_tr_b16 v[120:121], v10 offset:12544
  v_mfma_f32_16x16x32_bf16 v[148:151], v[104:107], v[52:55], v[148:151]
  ds_read_b64_tr_b16 v[122:123], v10 offset:13568
  v_mfma_f32_16x16x32_bf16 v[152:155], v[108:111], v[48:51], v[152:155]
  ds_read_b64_tr_b16 v[124:125], v11 offset:12544
  v_mfma_f32_16x16x32_bf16 v[156:159], v[108:111], v[52:55], v[156:159]
  ds_read_b64_tr_b16 v[126:127], v11 offset:13568
  buffer_load_dwordx4 v[48:51], v8, s[8:11], s41 offen offset:2048
  buffer_load_dwordx4 v[52:55], v9, s[8:11], s41 offen offset:2048
  s_waitcnt vmcnt(14) lgkmcnt(0)
  v_mfma_f32_16x16x32_bf16 v[128:131], v[112:115], v[56:59], v[128:131]
  ds_read_b64_tr_b16 v[96:97], v10 offset:16384
  v_mfma_f32_16x16x32_bf16 v[132:135], v[112:115], v[60:63], v[132:135]
  ds_read_b64_tr_b16 v[98:99], v10 offset:17408
  v_mfma_f32_16x16x32_bf16 v[136:139], v[116:119], v[56:59], v[136:139]
  ds_read_b64_tr_b16 v[100:101], v11 offset:16384
  v_mfma_f32_16x16x32_bf16 v[140:143], v[116:119], v[60:63], v[140:143]
  ds_read_b64_tr_b16 v[102:103], v11 offset:17408
  v_mfma_f32_16x16x32_bf16 v[144:147], v[120:123], v[56:59], v[144:147]
  ds_read_b64_tr_b16 v[104:105], v10 offset:16640
  v_mfma_f32_16x16x32_bf16 v[148:151], v[120:123], v[60:63], v[148:151]
  ds_read_b64_tr_b16 v[106:107], v10 offset:17664
  v_mfma_f32_16x16x32_bf16 v[152:155], v[124:127], v[56:59], v[152:155]
  ds_read_b64_tr_b16 v[108:109], v11 offset:16640
  v_mfma_f32_16x16x32_bf16 v[156:159], v[124:127], v[60:63], v[156:159]
  ds_read_b64_tr_b16 v[110:111], v11 offset:17664
  buffer_load_dwordx4 v[56:59], v8, s[8:11], s41 offen offset:3072
  buffer_load_dwordx4 v[60:63], v9, s[8:11], s41 offen offset:3072
  s_waitcnt vmcnt(14) lgkmcnt(0)
  v_mfma_f32_16x16x32_bf16 v[128:131], v[96:99], v[64:67], v[128:131]
  ds_read_b64_tr_b16 v[112:113], v10 offset:20480
  v_mfma_f32_16x16x32_bf16 v[132:135], v[96:99], v[68:71], v[132:135]
  ds_read_b64_tr_b16 v[114:115], v10 offset:21504
  v_mfma_f32_16x16x32_bf16 v[136:139], v[100:103], v[64:67], v[136:139]
  ds_read_b64_tr_b16 v[116:117], v11 offset:20480
  v_mfma_f32_16x16x32_bf16 v[140:143], v[100:103], v[68:71], v[140:143]
  ds_read_b64_tr_b16 v[118:119], v11 offset:21504
  v_mfma_f32_16x16x32_bf16 v[144:147], v[104:107], v[64:67], v[144:147]
  ds_read_b64_tr_b16 v[120:121], v10 offset:20736
  v_mfma_f32_16x16x32_bf16 v[148:151], v[104:107], v[68:71], v[148:151]
  ds_read_b64_tr_b16 v[122:123], v10 offset:21760
  v_mfma_f32_16x16x32_bf16 v[152:155], v[108:111], v[64:67], v[152:155]
  ds_read_b64_tr_b16 v[124:125], v11 offset:20736
  v_mfma_f32_16x16x32_bf16 v[156:159], v[108:111], v[68:71], v[156:159]
  ds_read_b64_tr_b16 v[126:127], v11 offset:21760
  buffer_load_dwordx4 v[64:67], v8, s[8:11], s42 offen offset:0
  buffer_load_dwordx4 v[68:71], v9, s[8:11], s42 offen offset:0
  s_waitcnt vmcnt(14) lgkmcnt(0)
  v_mfma_f32_16x16x32_bf16 v[128:131], v[112:115], v[72:75], v[128:131]
  ds_read_b64_tr_b16 v[96:97], v10 offset:24576
  v_mfma_f32_16x16x32_bf16 v[132:135], v[112:115], v[76:79], v[132:135]
  ds_read_b64_tr_b16 v[98:99], v10 offset:25600
  v_mfma_f32_16x16x32_bf16 v[136:139], v[116:119], v[72:75], v[136:139]
  ds_read_b64_tr_b16 v[100:101], v11 offset:24576
  v_mfma_f32_16x16x32_bf16 v[140:143], v[116:119], v[76:79], v[140:143]
  ds_read_b64_tr_b16 v[102:103], v11 offset:25600
  v_mfma_f32_16x16x32_bf16 v[144:147], v[120:123], v[72:75], v[144:147]
  ds_read_b64_tr_b16 v[104:105], v10 offset:24832
  v_mfma_f32_16x16x32_bf16 v[148:151], v[120:123], v[76:79], v[148:151]
  ds_read_b64_tr_b16 v[106:107], v10 offset:25856
  v_mfma_f32_16x16x32_bf16 v[152:155], v[124:127], v[72:75], v[152:155]
  ds_read_b64_tr_b16 v[108:109], v11 offset:24832
  v_mfma_f32_16x16x32_bf16 v[156:159], v[124:127], v[76:79], v[156:159]
  ds_read_b64_tr_b16 v[110:111], v11 offset:25856
  buffer_load_dwordx4 v[72:75], v8, s[8:11], s42 offen offset:1024
  buffer_load_dwordx4 v[76:79], v9, s[8:11], s42 offen offset:1024
  s_waitcnt vmcnt(14) lgkmcnt(0)
  v_mfma_f32_16x16x32_bf16 v[128:131], v[96:99], v[80:83], v[128:131]
  ds_read_b64_tr_b16 v[112:113], v10 offset:28672
  v_mfma_f32_16x16x32_bf16 v[132:135], v[96:99], v[84:87], v[132:135]
  ds_read_b64_tr_b16 v[114:115], v10 offset:29696
  v_mfma_f32_16x16x32_bf16 v[136:139], v[100:103], v[80:83], v[136:139]
  ds_read_b64_tr_b16 v[116:117], v11 offset:28672
  v_mfma_f32_16x16x32_bf16 v[140:143], v[100:103], v[84:87], v[140:143]
  ds_read_b64_tr_b16 v[118:119], v11 offset:29696
  v_mfma_f32_16x16x32_bf16 v[144:147], v[104:107], v[80:83], v[144:147]
  ds_read_b64_tr_b16 v[120:121], v10 offset:28928
  v_mfma_f32_16x16x32_bf16 v[148:151], v[104:107], v[84:87], v[148:151]
  ds_read_b64_tr_b16 v[122:123], v10 offset:29952
  v_mfma_f32_16x16x32_bf16 v[152:155], v[108:111], v[80:83], v[152:155]
  ds_read_b64_tr_b16 v[124:125], v11 offset:28928
  v_mfma_f32_16x16x32_bf16 v[156:159], v[108:111], v[84:87], v[156:159]
  ds_read_b64_tr_b16 v[126:127], v11 offset:29952
  buffer_load_dwordx4 v[80:83], v8, s[8:11], s42 offen offset:2048
  buffer_load_dwordx4 v[84:87], v9, s[8:11], s42 offen offset:2048
  s_waitcnt vmcnt(14) lgkmcnt(0)
  v_mfma_f32_16x16x32_bf16 v[128:131], v[112:115], v[88:91], v[128:131]
  ds_read_b64_tr_b16 v[96:97], v10 offset:32768
  v_mfma_f32_16x16x32_bf16 v[132:135], v[112:115], v[92:95], v[132:135]
  ds_read_b64_tr_b16 v[98:99], v10 offset:33792
  v_mfma_f32_16x16x32_bf16 v[136:139], v[116:119], v[88:91], v[136:139]
  ds_read_b64_tr_b16 v[100:101], v11 offset:32768
  v_mfma_f32_16x16x32_bf16 v[140:143], v[116:119], v[92:95], v[140:143]
  ds_read_b64_tr_b16 v[102:103], v11 offset:33792
  v_mfma_f32_16x16x32_bf16 v[144:147], v[120:123], v[88:91], v[144:147]
  ds_read_b64_tr_b16 v[104:105], v10 offset:33024
  v_mfma_f32_16x16x32_bf16 v[148:151], v[120:123], v[92:95], v[148:151]
  ds_read_b64_tr_b16 v[106:107], v10 offset:34048
  v_mfma_f32_16x16x32_bf16 v[152:155], v[124:127], v[88:91], v[152:155]
  ds_read_b64_tr_b16 v[108:109], v11 offset:33024
  v_mfma_f32_16x16x32_bf16 v[156:159], v[124:127], v[92:95], v[156:159]
  ds_read_b64_tr_b16 v[110:111], v11 offset:34048
  buffer_load_dwordx4 v[88:91], v8, s[8:11], s42 offen offset:3072
  buffer_load_dwordx4 v[92:95], v9, s[8:11], s42 offen offset:3072
  s_add_u32 s41, s41, 8192
  s_add_u32 s42, s42, 8192
  v_add_u32 v10, 32768, v10
  v_add_u32 v11, 32768, v11
  v_add_u32 v12, 32768, v12
  v_add_u32 v13, 32768, v13
  s_sub_u32 s40, s40, 1
  s_cmp_lg_u32 s40, 0
  s_cbranch_scc1 wo_cloop
  s_waitcnt vmcnt(0) lgkmcnt(0)
  s_barrier
  s_lshl_b32 s43, s3, 12
  s_add_u32 s43, s43, 131072
  v_and_b32 v1, 15, v0
  v_lshrrev_b32 v2, 1, v1
  v_lshrrev_b32 v3, 5, v0
  v_xor_b32 v3, v3, v2
  v_lshlrev_b32 v3, 4, v3
  v_lshl_add_u32 v1, v1, 7, v3
  v_bfe_u32 v4, v0, 4, 1
  v_lshl_add_u32 v1, v4, 3, v1
  v_add_u32 v16, s43, v1
  v_xor_b32 v17, 32, v16
  v_xor_b32 v18, 64, v16
  v_xor_b32 v19, 96, v16
  ds_read_b64 v[32:33], v16 offset:0
  ds_read_b64 v[34:35], v17 offset:0
  ds_read_b64 v[36:37], v18 offset:0
  ds_read_b64 v[38:39], v19 offset:0
  ds_read_b64 v[40:41], v16 offset:2048
  ds_read_b64 v[42:43], v17 offset:2048
  ds_read_b64 v[44:45], v18 offset:2048
  ds_read_b64 v[46:47], v19 offset:2048
  s_lshl_b32 s43, s37, 3
  s_lshl_b32 s44, s3, 1
  s_add_u32 s43, s43, s44
  s_lshl_b32 s43, s43, 5
  s_lshl_b32 s44, s38, 1
  s_add_u32 s43, s43, s44
  s_lshl_b32 s43, s43, 10
  v_lshl_add_u32 v20, v0, 4, s43
  s_waitcnt lgkmcnt(0)
  v_lshlrev_b32 v22, 16, v32
  v_and_b32 v23, 0xffff0000, v32
  v_lshlrev_b32 v24, 16, v33
  v_and_b32 v25, 0xffff0000, v33
  v_pk_add_f32 v[128:129], v[128:129], v[22:23]
  v_pk_add_f32 v[130:131], v[130:131], v[24:25]
  v_lshlrev_b32 v22, 16, v34
  v_and_b32 v23, 0xffff0000, v34
  v_lshlrev_b32 v24, 16, v35
  v_and_b32 v25, 0xffff0000, v35
  v_pk_add_f32 v[136:137], v[136:137], v[22:23]
  v_pk_add_f32 v[138:139], v[138:139], v[24:25]
  v_lshlrev_b32 v22, 16, v36
  v_and_b32 v23, 0xffff0000, v36
  v_lshlrev_b32 v24, 16, v37
  v_and_b32 v25, 0xffff0000, v37
  v_pk_add_f32 v[144:145], v[144:145], v[22:23]
  v_pk_add_f32 v[146:147], v[146:147], v[24:25]
  v_lshlrev_b32 v22, 16, v38
  v_and_b32 v23, 0xffff0000, v38
  v_lshlrev_b32 v24, 16, v39
  v_and_b32 v25, 0xffff0000, v39
  v_pk_add_f32 v[152:153], v[152:153], v[22:23]
  v_pk_add_f32 v[154:155], v[154:155], v[24:25]
  v_cvt_pk_bf16_f32 v64, v128, v129
  v_cvt_pk_bf16_f32 v65, v130, v131
  v_cvt_pk_bf16_f32 v66, v136, v137
  v_cvt_pk_bf16_f32 v67, v138, v139
  s_mov_b32 s44, 0
  buffer_store_dwordx4 v[64:67], v20, s[16:19], s44 offen offset:0 sc1
  v_cvt_pk_bf16_f32 v68, v144, v145
  v_cvt_pk_bf16_f32 v69, v146, v147
  v_cvt_pk_bf16_f32 v70, v152, v153
  v_cvt_pk_bf16_f32 v71, v154, v155
  s_mov_b32 s44, 0
  buffer_store_dwordx4 v[68:71], v20, s[16:19], s44 offen offset:1024 sc1
  v_pk_add_f32 v[22:23], v[128:129], v[130:131]
  v_pk_mul_f32 v[24:25], v[128:129], v[128:129]
  v_pk_fma_f32 v[24:25], v[130:131], v[130:131], v[24:25]
  v_pk_add_f32 v[22:23], v[22:23], v[136:137]
  v_pk_fma_f32 v[24:25], v[136:137], v[136:137], v[24:25]
  v_pk_add_f32 v[22:23], v[22:23], v[138:139]
  v_pk_fma_f32 v[24:25], v[138:139], v[138:139], v[24:25]
  v_pk_add_f32 v[22:23], v[22:23], v[144:145]
  v_pk_fma_f32 v[24:25], v[144:145], v[144:145], v[24:25]
  v_pk_add_f32 v[22:23], v[22:23], v[146:147]
  v_pk_fma_f32 v[24:25], v[146:147], v[146:147], v[24:25]
  v_pk_add_f32 v[22:23], v[22:23], v[152:153]
  v_pk_fma_f32 v[24:25], v[152:153], v[152:153], v[24:25]
  v_pk_add_f32 v[22:23], v[22:23], v[154:155]
  v_pk_fma_f32 v[24:25], v[154:155], v[154:155], v[24:25]
  v_add_f32 v80, v22, v23
  v_add_f32 v81, v24, v25
  v_lshlrev_b32 v22, 16, v40
  v_and_b32 v23, 0xffff0000, v40
  v_lshlrev_b32 v24, 16, v41
  v_and_b32 v25, 0xffff0000, v41
  v_pk_add_f32 v[132:133], v[132:133], v[22:23]
  v_pk_add_f32 v[134:135], v[134:135], v[24:25]
  v_lshlrev_b32 v22, 16, v42
  v_and_b32 v23, 0xffff0000, v42
  v_lshlrev_b32 v24, 16, v43
  v_and_b32 v25, 0xffff0000, v43
  v_pk_add_f32 v[140:141], v[140:141], v[22:23]
  v_pk_add_f32 v[142:143], v[142:143], v[24:25]
  v_lshlrev_b32 v22, 16, v44
  v_and_b32 v23, 0xffff0000, v44
  v_lshlrev_b32 v24, 16, v45
  v_and_b32 v25, 0xffff0000, v45
  v_pk_add_f32 v[148:149], v[148:149], v[22:23]
  v_pk_add_f32 v[150:151], v[150:151], v[24:25]
  v_lshlrev_b32 v22, 16, v46
  v_and_b32 v23, 0xffff0000, v46
  v_lshlrev_b32 v24, 16, v47
  v_and_b32 v25, 0xffff0000, v47
  v_pk_add_f32 v[156:157], v[156:157], v[22:23]
  v_pk_add_f32 v[158:159], v[158:159], v[24:25]
  v_cvt_pk_bf16_f32 v72, v132, v133
  v_cvt_pk_bf16_f32 v73, v134, v135
  v_cvt_pk_bf16_f32 v74, v140, v141
  v_cvt_pk_bf16_f32 v75, v142, v143
  s_mov_b32 s44, 32768
  buffer_store_dwordx4 v[72:75], v20, s[16:19], s44 offen offset:0 sc1
  v_cvt_pk_bf16_f32 v76, v148, v149
  v_cvt_pk_bf16_f32 v77, v150, v151
  v_cvt_pk_bf16_f32 v78, v156, v157
  v_cvt_pk_bf16_f32 v79, v158, v159
  s_mov_b32 s44, 32768
  buffer_store_dwordx4 v[76:79], v20, s[16:19], s44 offen offset:1024 sc1
  v_pk_add_f32 v[22:23], v[132:133], v[134:135]
  v_pk_mul_f32 v[24:25], v[132:133], v[132:133]
  v_pk_fma_f32 v[24:25], v[134:135], v[134:135], v[24:25]
  v_pk_add_f32 v[22:23], v[22:23], v[140:141]
  v_pk_fma_f32 v[24:25], v[140:141], v[140:141], v[24:25]
  v_pk_add_f32 v[22:23], v[22:23], v[142:143]
  v_pk_fma_f32 v[24:25], v[142:143], v[142:143], v[24:25]
  v_pk_add_f32 v[22:23], v[22:23], v[148:149]
  v_pk_fma_f32 v[24:25], v[148:149], v[148:149], v[24:25]
  v_pk_add_f32 v[22:23], v[22:23], v[150:151]
  v_pk_fma_f32 v[24:25], v[150:151], v[150:151], v[24:25]
  v_pk_add_f32 v[22:23], v[22:23], v[156:157]
  v_pk_fma_f32 v[24:25], v[156:157], v[156:157], v[24:25]
  v_pk_add_f32 v[22:23], v[22:23], v[158:159]
  v_pk_fma_f32 v[24:25], v[158:159], v[158:159], v[24:25]
  v_add_f32 v82, v22, v23
  v_add_f32 v83, v24, v25
  v_mov_b32 v88, v80
  v_mov_b32 v89, v81
  v_mov_b32 v90, v82
  v_mov_b32 v91, v83
  s_nop 1
  v_permlane32_swap_b32 v88, v80
  v_permlane32_swap_b32 v89, v81
  v_permlane32_swap_b32 v90, v82
  v_permlane32_swap_b32 v91, v83
  s_nop 1
  v_add_f32 v80, v80, v88
  v_add_f32 v81, v81, v89
  v_add_f32 v82, v82, v90
  v_add_f32 v83, v83, v91
  v_mov_b32 v88, v80
  v_mov_b32 v89, v81
  v_mov_b32 v90, v82
  v_mov_b32 v91, v83
  s_nop 1
  v_permlane16_swap_b32 v88, v80
  v_permlane16_swap_b32 v89, v81
  v_permlane16_swap_b32 v90, v82
  v_permlane16_swap_b32 v91, v83
  s_nop 1
  v_add_f32 v80, v80, v88
  v_add_f32 v81, v81, v89
  v_add_f32 v82, v82, v90
  v_add_f32 v83, v83, v91
  v_cmp_le_u32 vcc, 16, v0
  s_lshl_b32 s43, s38, 14
  s_lshl_b32 s44, s37, 10
  s_add_u32 s43, s43, s44
  s_lshl_b32 s44, s3, 8
  s_add_u32 s43, s43, s44
  v_cndmask_b32 v22, v80, v82, vcc
  v_cndmask_b32 v23, v81, v83, vcc
  v_lshl_add_u32 v2, v0, 3, s43
  s_mov_b64 s[50:51], exec
  s_mov_b32 exec_lo, -1
  s_mov_b32 exec_hi, 0
  buffer_store_dwordx2 v[22:23], v2, s[24:27], 0 offen sc1
  s_mov_b64 exec, s[50:51]
  s_waitcnt vmcnt(0)
  s_barrier
C_w1:
  s_load_dwordx2 s[16:17], s[0:1], 80
  s_and_b32 s43, s2, 7
  s_lshr_b32 s44, s2, 3
  s_and_b32 s37, s43, 1
  s_mul_i32 s37, s37, 8
  s_and_b32 s45, s44, 7
  s_add_u32 s37, s37, s45
  s_lshr_b32 s38, s43, 1
  s_mul_i32 s38, s38, 4
  s_lshr_b32 s45, s44, 3
  s_add_u32 s38, s38, s45
  s_lshr_b32 s43, s3, 1
  s_mul_i32 s43, s43, 8192
  v_lshl_add_u32 v8, v0, 4, s43
  v_lshrrev_b32 v1, 4, v0
  v_mul_u32_u24 v9, 1792, v1
  v_bfe_u32 v1, v0, 2, 2
  v_lshl_add_u32 v9, v1, 6, v9
  v_and_b32 v1, 3, v0
  v_lshl_add_u32 v9, v1, 3, v9
  v_add_u32 v9, 16384, v9
  v_bfe_u32 v1, v0, 4, 1
  v_lshlrev_b32 v1, 5, v1
  s_and_b32 s43, s3, 1
  s_lshl_b32 s44, s43, 5
  v_xor_b32 v2, s44, v1
  v_add_u32 v2, 768, v2
  v_add_u32 v11, v9, v2
  s_mul_i32 s44, s43, 1024
  v_xor_b32 v2, 32, v1
  v_add3_u32 v10, v9, v2, s44
  v_add3_u32 v9, v9, v1, s44
  v_mov_b32 v32, 0
  v_mov_b32 v33, 0
  v_mov_b32 v34, 0
  v_mov_b32 v35, 0
  s_nop 1
  v_mfma_f32_32x32x16_bf16 v[128:143], v[32:35], v[32:35], 0
  v_mfma_f32_32x32x16_bf16 v[144:159], v[32:35], v[32:35], 0
  v_mfma_f32_32x32x16_bf16 v[160:175], v[32:35], v[32:35], 0
  v_mfma_f32_32x32x16_bf16 v[176:191], v[32:35], v[32:35], 0
  v_mfma_f32_32x32x16_bf16 v[192:207], v[32:35], v[32:35], 0
  v_mfma_f32_32x32x16_bf16 v[208:223], v[32:35], v[32:35], 0
  v_mfma_f32_32x32x16_bf16 v[224:239], v[32:35], v[32:35], 0
  s_waitcnt lgkmcnt(0)
  s_add_u32 s16, s16, 25165824
  s_addc_u32 s17, s17, 0
  s_mov_b32 s18, 14680064
  s_mov_b32 s19, 0x00020000
  v_mov_b32 v2, 0
  s_mov_b32 s43, 0x8000
w1_nonce:
  global_load_dword v3, v2, s[54:55] sc1
  s_sub_u32 s43, s43, 1
  s_waitcnt vmcnt(0)
  v_readfirstlane_b32 s33, v3
  s_cmp_eq_u32 s43, 0
  s_cbranch_scc1 w1_nonce_x
  s_cmp_eq_u32 s33, 0
  s_cbranch_scc1 w1_nonce
w1_nonce_x:
  s_barrier
  s_mov_b32 s39, 0
  s_barrier
  v_add_u32 v12, s39, v8
  v_add_u32 v13, s39, v9
  v_add_u32 v14, s39, v10
  v_add_u32 v15, s39, v11
  s_add_u32 s39, s39, 45056
  s_cmp_eq_u32 s39, 135168
  s_cselect_b32 s39, 0, s39
  ds_read_b128 v[32:35], v12 offset:0
  ds_read_b128 v[36:39], v12 offset:2048
  ds_read_b128 v[40:43], v12 offset:4096
  ds_read_b128 v[44:47], v12 offset:6144
  ds_read_b64_tr_b16 v[48:49], v13 offset:0
  ds_read_b64_tr_b16 v[50:51], v13 offset:7168
  ds_read_b64_tr_b16 v[52:53], v14 offset:0
  ds_read_b64_tr_b16 v[54:55], v14 offset:7168
  ds_read_b64_tr_b16 v[56:57], v13 offset:256
  ds_read_b64_tr_b16 v[58:59], v13 offset:7424
  ds_read_b64_tr_b16 v[60:61], v14 offset:256
  ds_read_b64_tr_b16 v[62:63], v14 offset:7424
  ds_read_b64_tr_b16 v[64:65], v13 offset:512
  ds_read_b64_tr_b16 v[66:67], v13 offset:7680
  ds_read_b64_tr_b16 v[68:69], v14 offset:512
  ds_read_b64_tr_b16 v[70:71], v14 offset:7680
  ds_read_b64_tr_b16 v[72:73], v15 offset:0
  ds_read_b64_tr_b16 v[74:75], v15 offset:7168
  s_mov_b32 s40, 8
  s_branch w1_c1
.p2align 6
w1_cloop:
  s_waitcnt lgkmcnt(0)
  s_barrier
  v_mfma_f32_16x16x32_bf16 v[128:131], v[92:95], v[76:79], v[128:131]
  ds_read_b128 v[32:35], v12 offset:0
  v_mfma_f32_16x16x32_bf16 v[132:135], v[92:95], v[80:83], v[132:135]
  ds_read_b128 v[36:39], v12 offset:2048
  v_mfma_f32_16x16x32_bf16 v[136:139], v[92:95], v[84:87], v[136:139]
  ds_read_b128 v[40:43], v12 offset:4096
  v_mfma_f32_16x16x32_bf16 v[140:143], v[92:95], v[88:91], v[140:143]
  ds_read_b128 v[44:47], v12 offset:6144
  v_mfma_f32_16x16x32_bf16 v[144:147], v[96:99], v[76:79], v[144:147]
  ds_read_b64_tr_b16 v[48:49], v13 offset:0
  v_mfma_f32_16x16x32_bf16 v[148:151], v[96:99], v[80:83], v[148:151]
  ds_read_b64_tr_b16 v[50:51], v13 offset:7168
  v_mfma_f32_16x16x32_bf16 v[152:155], v[96:99], v[84:87], v[152:155]
  ds_read_b64_tr_b16 v[52:53], v14 offset:0
  v_mfma_f32_16x16x32_bf16 v[156:159], v[96:99], v[88:91], v[156:159]
  ds_read_b64_tr_b16 v[54:55], v14 offset:7168
  v_mfma_f32_16x16x32_bf16 v[160:163], v[100:103], v[76:79], v[160:163]
  ds_read_b64_tr_b16 v[56:57], v13 offset:256
  v_mfma_f32_16x16x32_bf16 v[164:167], v[100:103], v[80:83], v[164:167]
  ds_read_b64_tr_b16 v[58:59], v13 offset:7424
  v_mfma_f32_16x16x32_bf16 v[168:171], v[100:103], v[84:87], v[168:171]
  ds_read_b64_tr_b16 v[60:61], v14 offset:256
  v_mfma_f32_16x16x32_bf16 v[172:175], v[100:103], v[88:91], v[172:175]
  ds_read_b64_tr_b16 v[62:63], v14 offset:7424
  v_mfma_f32_16x16x32_bf16 v[176:179], v[104:107], v[76:79], v[176:179]
  ds_read_b64_tr_b16 v[64:65], v13 offset:512
  v_mfma_f32_16x16x32_bf16 v[180:183], v[104:107], v[80:83], v[180:183]
  ds_read_b64_tr_b16 v[66:67], v13 offset:7680
  v_mfma_f32_16x16x32_bf16 v[184:187], v[104:107], v[84:87], v[184:187]
  ds_read_b64_tr_b16 v[68:69], v14 offset:512
  v_mfma_f32_16x16x32_bf16 v[188:191], v[104:107], v[88:91], v[188:191]
  ds_read_b64_tr_b16 v[70:71], v14 offset:7680
  v_mfma_f32_16x16x32_bf16 v[192:195], v[108:111], v[76:79], v[192:195]
  ds_read_b64_tr_b16 v[72:73], v15 offset:0
  v_mfma_f32_16x16x32_bf16 v[196:199], v[108:111], v[80:83], v[196:199]
  ds_read_b64_tr_b16 v[74:75], v15 offset:7168
  v_mfma_f32_16x16x32_bf16 v[200:203], v[108:111], v[84:87], v[200:203]
  v_mfma_f32_16x16x32_bf16 v[204:207], v[108:111], v[88:91], v[204:207]
  v_mfma_f32_16x16x32_bf16 v[208:211], v[112:115], v[76:79], v[208:211]
  v_mfma_f32_16x16x32_bf16 v[212:215], v[112:115], v[80:83], v[212:215]
  v_mfma_f32_16x16x32_bf16 v[216:219], v[112:115], v[84:87], v[216:219]
  v_mfma_f32_16x16x32_bf16 v[220:223], v[112:115], v[88:91], v[220:223]
  v_mfma_f32_16x16x32_bf16 v[224:227], v[116:119], v[76:79], v[224:227]
  v_mfma_f32_16x16x32_bf16 v[228:231], v[116:119], v[80:83], v[228:231]
  v_mfma_f32_16x16x32_bf16 v[232:235], v[116:119], v[84:87], v[232:235]
  v_mfma_f32_16x16x32_bf16 v[236:239], v[116:119], v[88:91], v[236:239]
w1_c1:
  s_waitcnt lgkmcnt(0)
  v_mfma_f32_16x16x32_bf16 v[128:131], v[48:51], v[32:35], v[128:131]
  ds_read_b128 v[76:79], v12 offset:1024
  v_mfma_f32_16x16x32_bf16 v[132:135], v[48:51], v[36:39], v[132:135]
  ds_read_b128 v[80:83], v12 offset:3072
  v_mfma_f32_16x16x32_bf16 v[136:139], v[48:51], v[40:43], v[136:139]
  ds_read_b128 v[84:87], v12 offset:5120
  v_mfma_f32_16x16x32_bf16 v[140:143], v[48:51], v[44:47], v[140:143]
  ds_read_b128 v[88:91], v12 offset:7168
  v_mfma_f32_16x16x32_bf16 v[144:147], v[52:55], v[32:35], v[144:147]
  ds_read_b64_tr_b16 v[92:93], v13 offset:14336
  v_mfma_f32_16x16x32_bf16 v[148:151], v[52:55], v[36:39], v[148:151]
  ds_read_b64_tr_b16 v[94:95], v13 offset:21504
  v_mfma_f32_16x16x32_bf16 v[152:155], v[52:55], v[40:43], v[152:155]
  ds_read_b64_tr_b16 v[96:97], v14 offset:14336
  v_mfma_f32_16x16x32_bf16 v[156:159], v[52:55], v[44:47], v[156:159]
  ds_read_b64_tr_b16 v[98:99], v14 offset:21504
  v_mfma_f32_16x16x32_bf16 v[160:163], v[56:59], v[32:35], v[160:163]
  ds_read_b64_tr_b16 v[100:101], v13 offset:14592
  v_mfma_f32_16x16x32_bf16 v[164:167], v[56:59], v[36:39], v[164:167]
  ds_read_b64_tr_b16 v[102:103], v13 offset:21760
  v_mfma_f32_16x16x32_bf16 v[168:171], v[56:59], v[40:43], v[168:171]
  ds_read_b64_tr_b16 v[104:105], v14 offset:14592
  v_mfma_f32_16x16x32_bf16 v[172:175], v[56:59], v[44:47], v[172:175]
  ds_read_b64_tr_b16 v[106:107], v14 offset:21760
  v_mfma_f32_16x16x32_bf16 v[176:179], v[60:63], v[32:35], v[176:179]
  ds_read_b64_tr_b16 v[108:109], v13 offset:14848
  v_mfma_f32_16x16x32_bf16 v[180:183], v[60:63], v[36:39], v[180:183]
  ds_read_b64_tr_b16 v[110:111], v13 offset:22016
  v_mfma_f32_16x16x32_bf16 v[184:187], v[60:63], v[40:43], v[184:187]
  ds_read_b64_tr_b16 v[112:113], v14 offset:14848
  v_mfma_f32_16x16x32_bf16 v[188:191], v[60:63], v[44:47], v[188:191]
  ds_read_b64_tr_b16 v[114:115], v14 offset:22016
  v_mfma_f32_16x16x32_bf16 v[192:195], v[64:67], v[32:35], v[192:195]
  ds_read_b64_tr_b16 v[116:117], v15 offset:14336
  v_mfma_f32_16x16x32_bf16 v[196:199], v[64:67], v[36:39], v[196:199]
  ds_read_b64_tr_b16 v[118:119], v15 offset:21504
  v_mfma_f32_16x16x32_bf16 v[200:203], v[64:67], v[40:43], v[200:203]
  v_add_u32 v16, s39, v8
  v_mfma_f32_16x16x32_bf16 v[204:207], v[64:67], v[44:47], v[204:207]
  v_add_u32 v17, s39, v9
  v_mfma_f32_16x16x32_bf16 v[208:211], v[68:71], v[32:35], v[208:211]
  v_add_u32 v18, s39, v10
  v_mfma_f32_16x16x32_bf16 v[212:215], v[68:71], v[36:39], v[212:215]
  v_add_u32 v19, s39, v11
  v_mfma_f32_16x16x32_bf16 v[216:219], v[68:71], v[40:43], v[216:219]
  s_add_u32 s39, s39, 45056
  v_mfma_f32_16x16x32_bf16 v[220:223], v[68:71], v[44:47], v[220:223]
  s_cmp_eq_u32 s39, 135168
  v_mfma_f32_16x16x32_bf16 v[224:227], v[72:75], v[32:35], v[224:227]
  s_cselect_b32 s39, 0, s39
  v_mfma_f32_16x16x32_bf16 v[228:231], v[72:75], v[36:39], v[228:231]
  v_mfma_f32_16x16x32_bf16 v[232:235], v[72:75], v[40:43], v[232:235]
  v_mfma_f32_16x16x32_bf16 v[236:239], v[72:75], v[44:47], v[236:239]
  s_waitcnt lgkmcnt(0)
  s_barrier
  v_mfma_f32_16x16x32_bf16 v[128:131], v[92:95], v[76:79], v[128:131]
  ds_read_b128 v[32:35], v16 offset:0
  v_mfma_f32_16x16x32_bf16 v[132:135], v[92:95], v[80:83], v[132:135]
  ds_read_b128 v[36:39], v16 offset:2048
  v_mfma_f32_16x16x32_bf16 v[136:139], v[92:95], v[84:87], v[136:139]
  ds_read_b128 v[40:43], v16 offset:4096
  v_mfma_f32_16x16x32_bf16 v[140:143], v[92:95], v[88:91], v[140:143]
  ds_read_b128 v[44:47], v16 offset:6144
  v_mfma_f32_16x16x32_bf16 v[144:147], v[96:99], v[76:79], v[144:147]
  ds_read_b64_tr_b16 v[48:49], v17 offset:0
  v_mfma_f32_16x16x32_bf16 v[148:151], v[96:99], v[80:83], v[148:151]
  ds_read_b64_tr_b16 v[50:51], v17 offset:7168
  v_mfma_f32_16x16x32_bf16 v[152:155], v[96:99], v[84:87], v[152:155]
  ds_read_b64_tr_b16 v[52:53], v18 offset:0
  v_mfma_f32_16x16x32_bf16 v[156:159], v[96:99], v[88:91], v[156:159]
  ds_read_b64_tr_b16 v[54:55], v18 offset:7168
  v_mfma_f32_16x16x32_bf16 v[160:163], v[100:103], v[76:79], v[160:163]
  ds_read_b64_tr_b16 v[56:57], v17 offset:256
  v_mfma_f32_16x16x32_bf16 v[164:167], v[100:103], v[80:83], v[164:167]
  ds_read_b64_tr_b16 v[58:59], v17 offset:7424
  v_mfma_f32_16x16x32_bf16 v[168:171], v[100:103], v[84:87], v[168:171]
  ds_read_b64_tr_b16 v[60:61], v18 offset:256
  v_mfma_f32_16x16x32_bf16 v[172:175], v[100:103], v[88:91], v[172:175]
  ds_read_b64_tr_b16 v[62:63], v18 offset:7424
  v_mfma_f32_16x16x32_bf16 v[176:179], v[104:107], v[76:79], v[176:179]
  ds_read_b64_tr_b16 v[64:65], v17 offset:512
  v_mfma_f32_16x16x32_bf16 v[180:183], v[104:107], v[80:83], v[180:183]
  ds_read_b64_tr_b16 v[66:67], v17 offset:7680
  v_mfma_f32_16x16x32_bf16 v[184:187], v[104:107], v[84:87], v[184:187]
  ds_read_b64_tr_b16 v[68:69], v18 offset:512
  v_mfma_f32_16x16x32_bf16 v[188:191], v[104:107], v[88:91], v[188:191]
  ds_read_b64_tr_b16 v[70:71], v18 offset:7680
  v_mfma_f32_16x16x32_bf16 v[192:195], v[108:111], v[76:79], v[192:195]
  ds_read_b64_tr_b16 v[72:73], v19 offset:0
  v_mfma_f32_16x16x32_bf16 v[196:199], v[108:111], v[80:83], v[196:199]
  ds_read_b64_tr_b16 v[74:75], v19 offset:7168
  v_mfma_f32_16x16x32_bf16 v[200:203], v[108:111], v[84:87], v[200:203]
  v_mfma_f32_16x16x32_bf16 v[204:207], v[108:111], v[88:91], v[204:207]
  v_mfma_f32_16x16x32_bf16 v[208:211], v[112:115], v[76:79], v[208:211]
  v_mfma_f32_16x16x32_bf16 v[212:215], v[112:115], v[80:83], v[212:215]
  v_mfma_f32_16x16x32_bf16 v[216:219], v[112:115], v[84:87], v[216:219]
  v_mfma_f32_16x16x32_bf16 v[220:223], v[112:115], v[88:91], v[220:223]
  v_mfma_f32_16x16x32_bf16 v[224:227], v[116:119], v[76:79], v[224:227]
  v_mfma_f32_16x16x32_bf16 v[228:231], v[116:119], v[80:83], v[228:231]
  v_mfma_f32_16x16x32_bf16 v[232:235], v[116:119], v[84:87], v[232:235]
  v_mfma_f32_16x16x32_bf16 v[236:239], v[116:119], v[88:91], v[236:239]
  s_waitcnt lgkmcnt(0)
  v_mfma_f32_16x16x32_bf16 v[128:131], v[48:51], v[32:35], v[128:131]
  ds_read_b128 v[76:79], v16 offset:1024
  v_mfma_f32_16x16x32_bf16 v[132:135], v[48:51], v[36:39], v[132:135]
  ds_read_b128 v[80:83], v16 offset:3072
  v_mfma_f32_16x16x32_bf16 v[136:139], v[48:51], v[40:43], v[136:139]
  ds_read_b128 v[84:87], v16 offset:5120
  v_mfma_f32_16x16x32_bf16 v[140:143], v[48:51], v[44:47], v[140:143]
  ds_read_b128 v[88:91], v16 offset:7168
  v_mfma_f32_16x16x32_bf16 v[144:147], v[52:55], v[32:35], v[144:147]
  ds_read_b64_tr_b16 v[92:93], v17 offset:14336
  v_mfma_f32_16x16x32_bf16 v[148:151], v[52:55], v[36:39], v[148:151]
  ds_read_b64_tr_b16 v[94:95], v17 offset:21504
  v_mfma_f32_16x16x32_bf16 v[152:155], v[52:55], v[40:43], v[152:155]
  ds_read_b64_tr_b16 v[96:97], v18 offset:14336
  v_mfma_f32_16x16x32_bf16 v[156:159], v[52:55], v[44:47], v[156:159]
  ds_read_b64_tr_b16 v[98:99], v18 offset:21504
  v_mfma_f32_16x16x32_bf16 v[160:163], v[56:59], v[32:35], v[160:163]
  ds_read_b64_tr_b16 v[100:101], v17 offset:14592
  v_mfma_f32_16x16x32_bf16 v[164:167], v[56:59], v[36:39], v[164:167]
  ds_read_b64_tr_b16 v[102:103], v17 offset:21760
  v_mfma_f32_16x16x32_bf16 v[168:171], v[56:59], v[40:43], v[168:171]
  ds_read_b64_tr_b16 v[104:105], v18 offset:14592
  v_mfma_f32_16x16x32_bf16 v[172:175], v[56:59], v[44:47], v[172:175]
  ds_read_b64_tr_b16 v[106:107], v18 offset:21760
  v_mfma_f32_16x16x32_bf16 v[176:179], v[60:63], v[32:35], v[176:179]
  ds_read_b64_tr_b16 v[108:109], v17 offset:14848
  v_mfma_f32_16x16x32_bf16 v[180:183], v[60:63], v[36:39], v[180:183]
  ds_read_b64_tr_b16 v[110:111], v17 offset:22016
  v_mfma_f32_16x16x32_bf16 v[184:187], v[60:63], v[40:43], v[184:187]
  ds_read_b64_tr_b16 v[112:113], v18 offset:14848
  v_mfma_f32_16x16x32_bf16 v[188:191], v[60:63], v[44:47], v[188:191]
  ds_read_b64_tr_b16 v[114:115], v18 offset:22016
  v_mfma_f32_16x16x32_bf16 v[192:195], v[64:67], v[32:35], v[192:195]
  ds_read_b64_tr_b16 v[116:117], v19 offset:14336
  v_mfma_f32_16x16x32_bf16 v[196:199], v[64:67], v[36:39], v[196:199]
  ds_read_b64_tr_b16 v[118:119], v19 offset:21504
  v_mfma_f32_16x16x32_bf16 v[200:203], v[64:67], v[40:43], v[200:203]
  v_add_u32 v12, s39, v8
  v_mfma_f32_16x16x32_bf16 v[204:207], v[64:67], v[44:47], v[204:207]
  v_add_u32 v13, s39, v9
  v_mfma_f32_16x16x32_bf16 v[208:211], v[68:71], v[32:35], v[208:211]
  v_add_u32 v14, s39, v10
  v_mfma_f32_16x16x32_bf16 v[212:215], v[68:71], v[36:39], v[212:215]
  v_add_u32 v15, s39, v11
  v_mfma_f32_16x16x32_bf16 v[216:219], v[68:71], v[40:43], v[216:219]
  s_add_u32 s39, s39, 45056
  v_mfma_f32_16x16x32_bf16 v[220:223], v[68:71], v[44:47], v[220:223]
  s_cmp_eq_u32 s39, 135168
  v_mfma_f32_16x16x32_bf16 v[224:227], v[72:75], v[32:35], v[224:227]
  s_cselect_b32 s39, 0, s39
  v_mfma_f32_16x16x32_bf16 v[228:231], v[72:75], v[36:39], v[228:231]
  s_sub_u32 s40, s40, 1
  v_mfma_f32_16x16x32_bf16 v[232:235], v[72:75], v[40:43], v[232:235]
  s_cmp_lg_u32 s40, 0
  v_mfma_f32_16x16x32_bf16 v[236:239], v[72:75], v[44:47], v[236:239]
  s_cbranch_scc1 w1_cloop
  s_waitcnt lgkmcnt(0)
  s_barrier
  v_mfma_f32_16x16x32_bf16 v[128:131], v[92:95], v[76:79], v[128:131]
  v_mfma_f32_16x16x32_bf16 v[132:135], v[92:95], v[80:83], v[132:135]
  v_mfma_f32_16x16x32_bf16 v[136:139], v[92:95], v[84:87], v[136:139]
  v_mfma_f32_16x16x32_bf16 v[140:143], v[92:95], v[88:91], v[140:143]
  v_mfma_f32_16x16x32_bf16 v[144:147], v[96:99], v[76:79], v[144:147]
  v_mfma_f32_16x16x32_bf16 v[148:151], v[96:99], v[80:83], v[148:151]
  v_mfma_f32_16x16x32_bf16 v[152:155], v[96:99], v[84:87], v[152:155]
  v_mfma_f32_16x16x32_bf16 v[156:159], v[96:99], v[88:91], v[156:159]
  v_mfma_f32_16x16x32_bf16 v[160:163], v[100:103], v[76:79], v[160:163]
  v_mfma_f32_16x16x32_bf16 v[164:167], v[100:103], v[80:83], v[164:167]
  v_mfma_f32_16x16x32_bf16 v[168:171], v[100:103], v[84:87], v[168:171]
  v_mfma_f32_16x16x32_bf16 v[172:175], v[100:103], v[88:91], v[172:175]
  v_mfma_f32_16x16x32_bf16 v[176:179], v[104:107], v[76:79], v[176:179]
  v_mfma_f32_16x16x32_bf16 v[180:183], v[104:107], v[80:83], v[180:183]
  v_mfma_f32_16x16x32_bf16 v[184:187], v[104:107], v[84:87], v[184:187]
  v_mfma_f32_16x16x32_bf16 v[188:191], v[104:107], v[88:91], v[188:191]
  v_mfma_f32_16x16x32_bf16 v[192:195], v[108:111], v[76:79], v[192:195]
  v_mfma_f32_16x16x32_bf16 v[196:199], v[108:111], v[80:83], v[196:199]
  v_mfma_f32_16x16x32_bf16 v[200:203], v[108:111], v[84:87], v[200:203]
  v_mfma_f32_16x16x32_bf16 v[204:207], v[108:111], v[88:91], v[204:207]
  v_mfma_f32_16x16x32_bf16 v[208:211], v[112:115], v[76:79], v[208:211]
  v_mfma_f32_16x16x32_bf16 v[212:215], v[112:115], v[80:83], v[212:215]
  v_mfma_f32_16x16x32_bf16 v[216:219], v[112:115], v[84:87], v[216:219]
  v_mfma_f32_16x16x32_bf16 v[220:223], v[112:115], v[88:91], v[220:223]
  v_mfma_f32_16x16x32_bf16 v[224:227], v[116:119], v[76:79], v[224:227]
  v_mfma_f32_16x16x32_bf16 v[228:231], v[116:119], v[80:83], v[228:231]
  v_mfma_f32_16x16x32_bf16 v[232:235], v[116:119], v[84:87], v[232:235]
  v_mfma_f32_16x16x32_bf16 v[236:239], v[116:119], v[88:91], v[236:239]
  s_nop 7
  s_lshr_b32 s43, s3, 1
  s_lshl_b32 s43, s43, 9
  s_add_u32 s43, s43, 135168
  v_and_b32 v1, 15, v0
  v_lshl_add_u32 v1, v1, 3, s43
  ds_read_b64 v[16:17], v1 offset:0
  ds_read_b64 v[18:19], v1 offset:128
  ds_read_b64 v[20:21], v1 offset:256
  ds_read_b64 v[22:23], v1 offset:384
  s_and_b32 s43, s3, 1
  v_lshrrev_b32 v2, 4, v0
  v_lshlrev_b32 v2, 4, v2
  v_add_u32 v2, 136192, v2
  s_lshl_b32 s44, s43, 9
  v_add_u32 v3, s44, v2
  s_lshl_b32 s44, s43, 6
  s_add_u32 s44, s44, 384
  v_add_u32 v4, s44, v2
  ds_read_b128 v[32:35], v3 offset:0
  ds_read_b128 v[36:39], v3 offset:896
  ds_read_b128 v[40:43], v3 offset:64
  ds_read_b128 v[44:47], v3 offset:960
  ds_read_b128 v[48:51], v3 offset:128
  ds_read_b128 v[52:55], v3 offset:1024
  ds_read_b128 v[56:59], v3 offset:192
  ds_read_b128 v[60:63], v3 offset:1088
  ds_read_b128 v[64:67], v3 offset:256
  ds_read_b128 v[68:71], v3 offset:1152
  ds_read_b128 v[72:75], v3 offset:320
  ds_read_b128 v[76:79], v3 offset:1216
  ds_read_b128 v[80:83], v4 offset:0
  ds_read_b128 v[84:87], v4 offset:896
  s_lshl_b32 s44, s37, 3
  s_and_b32 s45, s3, 2
  s_lshl_b32 s45, s45, 1
  s_add_u32 s44, s44, s45
  s_mul_i32 s44, s44, 112
  s_mul_i32 s45, s38, 7
  s_add_u32 s44, s44, s45
  s_lshl_b32 s44, s44, 10
  s_lshl_b32 s45, s43, 12
  s_add_u32 s45, s45, s44
  v_lshl_add_u32 v5, v0, 4, s45
  s_lshl_b32 s45, s43, 3
  s_add_u32 s45, s45, s44
  s_add_u32 s45, s45, 3072
  v_lshl_add_u32 v6, v0, 4, s45
  s_mov_b32 s52, 3184710632
  s_mov_b32 s53, 3184710632
  v_mov_b32 v112, 3222493025
  v_mov_b32 v113, 3222493025
  s_waitcnt lgkmcnt(0)
  s_and_b32 s48, s3, 2
  s_lshl_b32 s48, s48, 12
  v_lshl_add_u32 v7, v0, 4, s48
  s_and_b32 s49, s3, 1
  s_lshl_b32 s48, s49, 16
  v_add_u32 v24, s48, v7
  s_lshl_b32 s48, s49, 3
  s_add_u32 s48, s48, 33792
  v_add_u32 v25, s48, v7
  v_pk_fma_f32 v[96:97], v[80:81], v[16:17], v[84:85] op_sel:[0,1,0] op_sel_hi:[1,1,1]
  v_pk_fma_f32 v[100:101], v[82:83], v[16:17], v[86:87] op_sel:[0,1,0] op_sel_hi:[1,1,1]
  v_pk_fma_f32 v[104:105], v[80:81], v[18:19], v[84:85] op_sel:[0,1,0] op_sel_hi:[1,1,1]
  v_pk_fma_f32 v[108:109], v[82:83], v[18:19], v[86:87] op_sel:[0,1,0] op_sel_hi:[1,1,1]
  v_pk_fma_f32 v[224:225], v[224:225], v[16:17], v[96:97] op_sel_hi:[1,0,1]
  v_pk_fma_f32 v[226:227], v[226:227], v[16:17], v[100:101] op_sel_hi:[1,0,1]
  v_pk_fma_f32 v[228:229], v[228:229], v[18:19], v[104:105] op_sel_hi:[1,0,1]
  v_pk_fma_f32 v[230:231], v[230:231], v[18:19], v[108:109] op_sel_hi:[1,0,1]
  v_pk_mul_f32 v[96:97], v[224:225], v[224:225]
  v_pk_mul_f32 v[100:101], v[226:227], v[226:227]
  v_pk_mul_f32 v[104:105], v[228:229], v[228:229]
  v_pk_mul_f32 v[108:109], v[230:231], v[230:231]
  v_pk_fma_f32 v[96:97], v[96:97], s[52:53], v[112:113]
  v_pk_fma_f32 v[100:101], v[100:101], s[52:53], v[112:113]
  v_pk_fma_f32 v[104:105], v[104:105], s[52:53], v[112:113]
  v_pk_fma_f32 v[108:109], v[108:109], s[52:53], v[112:113]
  v_pk_mul_f32 v[96:97], v[96:97], v[224:225]
  v_pk_mul_f32 v[100:101], v[100:101], v[226:227]
  v_pk_mul_f32 v[104:105], v[104:105], v[228:229]
  v_pk_mul_f32 v[108:109], v[108:109], v[230:231]
  v_exp_f32 v96, v96
  v_exp_f32 v97, v97
  v_exp_f32 v100, v100
  v_exp_f32 v101, v101
  v_exp_f32 v104, v104
  v_exp_f32 v105, v105
  v_exp_f32 v108, v108
  v_exp_f32 v109, v109
  v_pk_add_f32 v[96:97], v[96:97], 1.0 op_sel_hi:[1,0]
  v_pk_add_f32 v[100:101], v[100:101], 1.0 op_sel_hi:[1,0]
  v_pk_add_f32 v[104:105], v[104:105], 1.0 op_sel_hi:[1,0]
  v_pk_add_f32 v[108:109], v[108:109], 1.0 op_sel_hi:[1,0]
  v_rcp_f32 v96, v96
  v_rcp_f32 v97, v97
  v_rcp_f32 v100, v100
  v_rcp_f32 v101, v101
  v_rcp_f32 v104, v104
  v_rcp_f32 v105, v105
  v_rcp_f32 v108, v108
  v_rcp_f32 v109, v109
  v_pk_mul_f32 v[224:225], v[224:225], v[96:97]
  v_pk_mul_f32 v[226:227], v[226:227], v[100:101]
  v_pk_mul_f32 v[228:229], v[228:229], v[104:105]
  v_pk_mul_f32 v[230:231], v[230:231], v[108:109]
  v_cvt_pk_bf16_f32 v116, v224, v225
  v_cvt_pk_bf16_f32 v117, v226, v227
  v_cvt_pk_bf16_f32 v118, v228, v229
  v_cvt_pk_bf16_f32 v119, v230, v231
  s_mov_b32 s44, 0
  buffer_store_dwordx2 v[116:117], v6, s[16:19], s44 offen sc1
  ds_write_b64 v25, v[116:117] offset:0
  s_mov_b32 s44, 114688
  buffer_store_dwordx2 v[118:119], v6, s[16:19], s44 offen sc1
  ds_write_b64 v25, v[118:119] offset:2048
  v_pk_fma_f32 v[96:97], v[80:81], v[20:21], v[84:85] op_sel:[0,1,0] op_sel_hi:[1,1,1]
  v_pk_fma_f32 v[100:101], v[82:83], v[20:21], v[86:87] op_sel:[0,1,0] op_sel_hi:[1,1,1]
  v_pk_fma_f32 v[104:105], v[80:81], v[22:23], v[84:85] op_sel:[0,1,0] op_sel_hi:[1,1,1]
  v_pk_fma_f32 v[108:109], v[82:83], v[22:23], v[86:87] op_sel:[0,1,0] op_sel_hi:[1,1,1]
  v_pk_fma_f32 v[232:233], v[232:233], v[20:21], v[96:97] op_sel_hi:[1,0,1]
  v_pk_fma_f32 v[234:235], v[234:235], v[20:21], v[100:101] op_sel_hi:[1,0,1]
  v_pk_fma_f32 v[236:237], v[236:237], v[22:23], v[104:105] op_sel_hi:[1,0,1]
  v_pk_fma_f32 v[238:239], v[238:239], v[22:23], v[108:109] op_sel_hi:[1,0,1]
  v_pk_mul_f32 v[96:97], v[232:233], v[232:233]
  v_pk_mul_f32 v[100:101], v[234:235], v[234:235]
  v_pk_mul_f32 v[104:105], v[236:237], v[236:237]
  v_pk_mul_f32 v[108:109], v[238:239], v[238:239]
  v_pk_fma_f32 v[96:97], v[96:97], s[52:53], v[112:113]
  v_pk_fma_f32 v[100:101], v[100:101], s[52:53], v[112:113]
  v_pk_fma_f32 v[104:105], v[104:105], s[52:53], v[112:113]
  v_pk_fma_f32 v[108:109], v[108:109], s[52:53], v[112:113]
  v_pk_mul_f32 v[96:97], v[96:97], v[232:233]
  v_pk_mul_f32 v[100:101], v[100:101], v[234:235]
  v_pk_mul_f32 v[104:105], v[104:105], v[236:237]
  v_pk_mul_f32 v[108:109], v[108:109], v[238:239]
  v_exp_f32 v96, v96
  v_exp_f32 v97, v97
  v_exp_f32 v100, v100
  v_exp_f32 v101, v101
  v_exp_f32 v104, v104
  v_exp_f32 v105, v105
  v_exp_f32 v108, v108
  v_exp_f32 v109, v109
  v_pk_add_f32 v[96:97], v[96:97], 1.0 op_sel_hi:[1,0]
  v_pk_add_f32 v[100:101], v[100:101], 1.0 op_sel_hi:[1,0]
  v_pk_add_f32 v[104:105], v[104:105], 1.0 op_sel_hi:[1,0]
  v_pk_add_f32 v[108:109], v[108:109], 1.0 op_sel_hi:[1,0]
  v_rcp_f32 v96, v96
  v_rcp_f32 v97, v97
  v_rcp_f32 v100, v100
  v_rcp_f32 v101, v101
  v_rcp_f32 v104, v104
  v_rcp_f32 v105, v105
  v_rcp_f32 v108, v108
  v_rcp_f32 v109, v109
  v_pk_mul_f32 v[232:233], v[232:233], v[96:97]
  v_pk_mul_f32 v[234:235], v[234:235], v[100:101]
  v_pk_mul_f32 v[236:237], v[236:237], v[104:105]
  v_pk_mul_f32 v[238:239], v[238:239], v[108:109]
  v_cvt_pk_bf16_f32 v120, v232, v233
  v_cvt_pk_bf16_f32 v121, v234, v235
  v_cvt_pk_bf16_f32 v122, v236, v237
  v_cvt_pk_bf16_f32 v123, v238, v239
  s_mov_b32 s44, 229376
  buffer_store_dwordx2 v[120:121], v6, s[16:19], s44 offen sc1
  ds_write_b64 v25, v[120:121] offset:4096
  s_mov_b32 s44, 344064
  buffer_store_dwordx2 v[122:123], v6, s[16:19], s44 offen sc1
  ds_write_b64 v25, v[122:123] offset:6144
  v_pk_fma_f32 v[96:97], v[32:33], v[16:17], v[36:37] op_sel:[0,1,0] op_sel_hi:[1,1,1]
  v_pk_fma_f32 v[100:101], v[34:35], v[16:17], v[38:39] op_sel:[0,1,0] op_sel_hi:[1,1,1]
  v_pk_fma_f32 v[104:105], v[40:41], v[16:17], v[44:45] op_sel:[0,1,0] op_sel_hi:[1,1,1]
  v_pk_fma_f32 v[108:109], v[42:43], v[16:17], v[46:47] op_sel:[0,1,0] op_sel_hi:[1,1,1]
  v_pk_fma_f32 v[128:129], v[128:129], v[16:17], v[96:97] op_sel_hi:[1,0,1]
  v_pk_fma_f32 v[130:131], v[130:131], v[16:17], v[100:101] op_sel_hi:[1,0,1]
  v_pk_fma_f32 v[144:145], v[144:145], v[16:17], v[104:105] op_sel_hi:[1,0,1]
  v_pk_fma_f32 v[146:147], v[146:147], v[16:17], v[108:109] op_sel_hi:[1,0,1]
  v_pk_mul_f32 v[96:97], v[128:129], v[128:129]
  v_pk_mul_f32 v[100:101], v[130:131], v[130:131]
  v_pk_mul_f32 v[104:105], v[144:145], v[144:145]
  v_pk_mul_f32 v[108:109], v[146:147], v[146:147]
  v_pk_fma_f32 v[96:97], v[96:97], s[52:53], v[112:113]
  v_pk_fma_f32 v[100:101], v[100:101], s[52:53], v[112:113]
  v_pk_fma_f32 v[104:105], v[104:105], s[52:53], v[112:113]
  v_pk_fma_f32 v[108:109], v[108:109], s[52:53], v[112:113]
  v_pk_mul_f32 v[96:97], v[96:97], v[128:129]
  v_pk_mul_f32 v[100:101], v[100:101], v[130:131]
  v_pk_mul_f32 v[104:105], v[104:105], v[144:145]
  v_pk_mul_f32 v[108:109], v[108:109], v[146:147]
  v_exp_f32 v96, v96
  v_exp_f32 v97, v97
  v_exp_f32 v100, v100
  v_exp_f32 v101, v101
  v_exp_f32 v104, v104
  v_exp_f32 v105, v105
  v_exp_f32 v108, v108
  v_exp_f32 v109, v109
  v_pk_add_f32 v[96:97], v[96:97], 1.0 op_sel_hi:[1,0]
  v_pk_add_f32 v[100:101], v[100:101], 1.0 op_sel_hi:[1,0]
  v_pk_add_f32 v[104:105], v[104:105], 1.0 op_sel_hi:[1,0]
  v_pk_add_f32 v[108:109], v[108:109], 1.0 op_sel_hi:[1,0]
  v_rcp_f32 v96, v96
  v_rcp_f32 v97, v97
  v_rcp_f32 v100, v100
  v_rcp_f32 v101, v101
  v_rcp_f32 v104, v104
  v_rcp_f32 v105, v105
  v_rcp_f32 v108, v108
  v_rcp_f32 v109, v109
  v_pk_mul_f32 v[128:129], v[128:129], v[96:97]
  v_pk_mul_f32 v[130:131], v[130:131], v[100:101]
  v_pk_mul_f32 v[144:145], v[144:145], v[104:105]
  v_pk_mul_f32 v[146:147], v[146:147], v[108:109]
  v_cvt_pk_bf16_f32 v116, v128, v129
  v_cvt_pk_bf16_f32 v117, v130, v131
  v_cvt_pk_bf16_f32 v118, v144, v145
  v_cvt_pk_bf16_f32 v119, v146, v147
  s_mov_b32 s44, 0
  buffer_store_dwordx4 v[116:119], v5, s[16:19], s44 offen sc1
  ds_write_b128 v24, v[116:119] offset:0
  v_pk_fma_f32 v[96:97], v[32:33], v[18:19], v[36:37] op_sel:[0,1,0] op_sel_hi:[1,1,1]
  v_pk_fma_f32 v[100:101], v[34:35], v[18:19], v[38:39] op_sel:[0,1,0] op_sel_hi:[1,1,1]
  v_pk_fma_f32 v[104:105], v[40:41], v[18:19], v[44:45] op_sel:[0,1,0] op_sel_hi:[1,1,1]
  v_pk_fma_f32 v[108:109], v[42:43], v[18:19], v[46:47] op_sel:[0,1,0] op_sel_hi:[1,1,1]
  v_pk_fma_f32 v[132:133], v[132:133], v[18:19], v[96:97] op_sel_hi:[1,0,1]
  v_pk_fma_f32 v[134:135], v[134:135], v[18:19], v[100:101] op_sel_hi:[1,0,1]
  v_pk_fma_f32 v[148:149], v[148:149], v[18:19], v[104:105] op_sel_hi:[1,0,1]
  v_pk_fma_f32 v[150:151], v[150:151], v[18:19], v[108:109] op_sel_hi:[1,0,1]
  v_pk_mul_f32 v[96:97], v[132:133], v[132:133]
  v_pk_mul_f32 v[100:101], v[134:135], v[134:135]
  v_pk_mul_f32 v[104:105], v[148:149], v[148:149]
  v_pk_mul_f32 v[108:109], v[150:151], v[150:151]
  v_pk_fma_f32 v[96:97], v[96:97], s[52:53], v[112:113]
  v_pk_fma_f32 v[100:101], v[100:101], s[52:53], v[112:113]
  v_pk_fma_f32 v[104:105], v[104:105], s[52:53], v[112:113]
  v_pk_fma_f32 v[108:109], v[108:109], s[52:53], v[112:113]
  v_pk_mul_f32 v[96:97], v[96:97], v[132:133]
  v_pk_mul_f32 v[100:101], v[100:101], v[134:135]
  v_pk_mul_f32 v[104:105], v[104:105], v[148:149]
  v_pk_mul_f32 v[108:109], v[108:109], v[150:151]
  v_exp_f32 v96, v96
  v_exp_f32 v97, v97
  v_exp_f32 v100, v100
  v_exp_f32 v101, v101
  v_exp_f32 v104, v104
  v_exp_f32 v105, v105
  v_exp_f32 v108, v108
  v_exp_f32 v109, v109
  v_pk_add_f32 v[96:97], v[96:97], 1.0 op_sel_hi:[1,0]
  v_pk_add_f32 v[100:101], v[100:101], 1.0 op_sel_hi:[1,0]
  v_pk_add_f32 v[104:105], v[104:105], 1.0 op_sel_hi:[1,0]
  v_pk_add_f32 v[108:109], v[108:109], 1.0 op_sel_hi:[1,0]
  v_rcp_f32 v96, v96
  v_rcp_f32 v97, v97
  v_rcp_f32 v100, v100
  v_rcp_f32 v101, v101
  v_rcp_f32 v104, v104
  v_rcp_f32 v105, v105
  v_rcp_f32 v108, v108
  v_rcp_f32 v109, v109
  v_pk_mul_f32 v[132:133], v[132:133], v[96:97]
  v_pk_mul_f32 v[134:135], v[134:135], v[100:101]
  v_pk_mul_f32 v[148:149], v[148:149], v[104:105]
  v_pk_mul_f32 v[150:151], v[150:151], v[108:109]
  v_cvt_pk_bf16_f32 v120, v132, v133
  v_cvt_pk_bf16_f32 v121, v134, v135
  v_cvt_pk_bf16_f32 v122, v148, v149
  v_cvt_pk_bf16_f32 v123, v150, v151
  s_mov_b32 s44, 114688
  buffer_store_dwordx4 v[120:123], v5, s[16:19], s44 offen sc1
  ds_write_b128 v24, v[120:123] offset:2048
  v_pk_fma_f32 v[96:97], v[32:33], v[20:21], v[36:37] op_sel:[0,1,0] op_sel_hi:[1,1,1]
  v_pk_fma_f32 v[100:101], v[34:35], v[20:21], v[38:39] op_sel:[0,1,0] op_sel_hi:[1,1,1]
  v_pk_fma_f32 v[104:105], v[40:41], v[20:21], v[44:45] op_sel:[0,1,0] op_sel_hi:[1,1,1]
  v_pk_fma_f32 v[108:109], v[42:43], v[20:21], v[46:47] op_sel:[0,1,0] op_sel_hi:[1,1,1]
  v_pk_fma_f32 v[136:137], v[136:137], v[20:21], v[96:97] op_sel_hi:[1,0,1]
  v_pk_fma_f32 v[138:139], v[138:139], v[20:21], v[100:101] op_sel_hi:[1,0,1]
  v_pk_fma_f32 v[152:153], v[152:153], v[20:21], v[104:105] op_sel_hi:[1,0,1]
  v_pk_fma_f32 v[154:155], v[154:155], v[20:21], v[108:109] op_sel_hi:[1,0,1]
  v_pk_mul_f32 v[96:97], v[136:137], v[136:137]
  v_pk_mul_f32 v[100:101], v[138:139], v[138:139]
  v_pk_mul_f32 v[104:105], v[152:153], v[152:153]
  v_pk_mul_f32 v[108:109], v[154:155], v[154:155]
  v_pk_fma_f32 v[96:97], v[96:97], s[52:53], v[112:113]
  v_pk_fma_f32 v[100:101], v[100:101], s[52:53], v[112:113]
  v_pk_fma_f32 v[104:105], v[104:105], s[52:53], v[112:113]
  v_pk_fma_f32 v[108:109], v[108:109], s[52:53], v[112:113]
  v_pk_mul_f32 v[96:97], v[96:97], v[136:137]
  v_pk_mul_f32 v[100:101], v[100:101], v[138:139]
  v_pk_mul_f32 v[104:105], v[104:105], v[152:153]
  v_pk_mul_f32 v[108:109], v[108:109], v[154:155]
  v_exp_f32 v96, v96
  v_exp_f32 v97, v97
  v_exp_f32 v100, v100
  v_exp_f32 v101, v101
  v_exp_f32 v104, v104
  v_exp_f32 v105, v105
  v_exp_f32 v108, v108
  v_exp_f32 v109, v109
  v_pk_add_f32 v[96:97], v[96:97], 1.0 op_sel_hi:[1,0]
  v_pk_add_f32 v[100:101], v[100:101], 1.0 op_sel_hi:[1,0]
  v_pk_add_f32 v[104:105], v[104:105], 1.0 op_sel_hi:[1,0]
  v_pk_add_f32 v[108:109], v[108:109], 1.0 op_sel_hi:[1,0]
  v_rcp_f32 v96, v96
  v_rcp_f32 v97, v97
  v_rcp_f32 v100, v100
  v_rcp_f32 v101, v101
  v_rcp_f32 v104, v104
  v_rcp_f32 v105, v105
  v_rcp_f32 v108, v108
  v_rcp_f32 v109, v109
  v_pk_mul_f32 v[136:137], v[136:137], v[96:97]
  v_pk_mul_f32 v[138:139], v[138:139], v[100:101]
  v_pk_mul_f32 v[152:153], v[152:153], v[104:105]
  v_pk_mul_f32 v[154:155], v[154:155], v[108:109]
  v_cvt_pk_bf16_f32 v116, v136, v137
  v_cvt_pk_bf16_f32 v117, v138, v139
  v_cvt_pk_bf16_f32 v118, v152, v153
  v_cvt_pk_bf16_f32 v119, v154, v155
  s_mov_b32 s44, 229376
  buffer_store_dwordx4 v[116:119], v5, s[16:19], s44 offen sc1
  ds_write_b128 v24, v[116:119] offset:4096
  v_pk_fma_f32 v[96:97], v[32:33], v[22:23], v[36:37] op_sel:[0,1,0] op_sel_hi:[1,1,1]
  v_pk_fma_f32 v[100:101], v[34:35], v[22:23], v[38:39] op_sel:[0,1,0] op_sel_hi:[1,1,1]
  v_pk_fma_f32 v[104:105], v[40:41], v[22:23], v[44:45] op_sel:[0,1,0] op_sel_hi:[1,1,1]
  v_pk_fma_f32 v[108:109], v[42:43], v[22:23], v[46:47] op_sel:[0,1,0] op_sel_hi:[1,1,1]
  v_pk_fma_f32 v[140:141], v[140:141], v[22:23], v[96:97] op_sel_hi:[1,0,1]
  v_pk_fma_f32 v[142:143], v[142:143], v[22:23], v[100:101] op_sel_hi:[1,0,1]
  v_pk_fma_f32 v[156:157], v[156:157], v[22:23], v[104:105] op_sel_hi:[1,0,1]
  v_pk_fma_f32 v[158:159], v[158:159], v[22:23], v[108:109] op_sel_hi:[1,0,1]
  v_pk_mul_f32 v[96:97], v[140:141], v[140:141]
  v_pk_mul_f32 v[100:101], v[142:143], v[142:143]
  v_pk_mul_f32 v[104:105], v[156:157], v[156:157]
  v_pk_mul_f32 v[108:109], v[158:159], v[158:159]
  v_pk_fma_f32 v[96:97], v[96:97], s[52:53], v[112:113]
  v_pk_fma_f32 v[100:101], v[100:101], s[52:53], v[112:113]
  v_pk_fma_f32 v[104:105], v[104:105], s[52:53], v[112:113]
  v_pk_fma_f32 v[108:109], v[108:109], s[52:53], v[112:113]
  v_pk_mul_f32 v[96:97], v[96:97], v[140:141]
  v_pk_mul_f32 v[100:101], v[100:101], v[142:143]
  v_pk_mul_f32 v[104:105], v[104:105], v[156:157]
  v_pk_mul_f32 v[108:109], v[108:109], v[158:159]
  v_exp_f32 v96, v96
  v_exp_f32 v97, v97
  v_exp_f32 v100, v100
  v_exp_f32 v101, v101
  v_exp_f32 v104, v104
  v_exp_f32 v105, v105
  v_exp_f32 v108, v108
  v_exp_f32 v109, v109
  v_pk_add_f32 v[96:97], v[96:97], 1.0 op_sel_hi:[1,0]
  v_pk_add_f32 v[100:101], v[100:101], 1.0 op_sel_hi:[1,0]
  v_pk_add_f32 v[104:105], v[104:105], 1.0 op_sel_hi:[1,0]
  v_pk_add_f32 v[108:109], v[108:109], 1.0 op_sel_hi:[1,0]
  v_rcp_f32 v96, v96
  v_rcp_f32 v97, v97
  v_rcp_f32 v100, v100
  v_rcp_f32 v101, v101
  v_rcp_f32 v104, v104
  v_rcp_f32 v105, v105
  v_rcp_f32 v108, v108
  v_rcp_f32 v109, v109
  v_pk_mul_f32 v[140:141], v[140:141], v[96:97]
  v_pk_mul_f32 v[142:143], v[142:143], v[100:101]
  v_pk_mul_f32 v[156:157], v[156:157], v[104:105]
  v_pk_mul_f32 v[158:159], v[158:159], v[108:109]
  v_cvt_pk_bf16_f32 v120, v140, v141
  v_cvt_pk_bf16_f32 v121, v142, v143
  v_cvt_pk_bf16_f32 v122, v156, v157
  v_cvt_pk_bf16_f32 v123, v158, v159
  s_mov_b32 s44, 344064
  buffer_store_dwordx4 v[120:123], v5, s[16:19], s44 offen sc1
  ds_write_b128 v24, v[120:123] offset:6144
  v_pk_fma_f32 v[96:97], v[48:49], v[16:17], v[52:53] op_sel:[0,1,0] op_sel_hi:[1,1,1]
  v_pk_fma_f32 v[100:101], v[50:51], v[16:17], v[54:55] op_sel:[0,1,0] op_sel_hi:[1,1,1]
  v_pk_fma_f32 v[104:105], v[56:57], v[16:17], v[60:61] op_sel:[0,1,0] op_sel_hi:[1,1,1]
  v_pk_fma_f32 v[108:109], v[58:59], v[16:17], v[62:63] op_sel:[0,1,0] op_sel_hi:[1,1,1]
  v_pk_fma_f32 v[160:161], v[160:161], v[16:17], v[96:97] op_sel_hi:[1,0,1]
  v_pk_fma_f32 v[162:163], v[162:163], v[16:17], v[100:101] op_sel_hi:[1,0,1]
  v_pk_fma_f32 v[176:177], v[176:177], v[16:17], v[104:105] op_sel_hi:[1,0,1]
  v_pk_fma_f32 v[178:179], v[178:179], v[16:17], v[108:109] op_sel_hi:[1,0,1]
  v_pk_mul_f32 v[96:97], v[160:161], v[160:161]
  v_pk_mul_f32 v[100:101], v[162:163], v[162:163]
  v_pk_mul_f32 v[104:105], v[176:177], v[176:177]
  v_pk_mul_f32 v[108:109], v[178:179], v[178:179]
  v_pk_fma_f32 v[96:97], v[96:97], s[52:53], v[112:113]
  v_pk_fma_f32 v[100:101], v[100:101], s[52:53], v[112:113]
  v_pk_fma_f32 v[104:105], v[104:105], s[52:53], v[112:113]
  v_pk_fma_f32 v[108:109], v[108:109], s[52:53], v[112:113]
  v_pk_mul_f32 v[96:97], v[96:97], v[160:161]
  v_pk_mul_f32 v[100:101], v[100:101], v[162:163]
  v_pk_mul_f32 v[104:105], v[104:105], v[176:177]
  v_pk_mul_f32 v[108:109], v[108:109], v[178:179]
  v_exp_f32 v96, v96
  v_exp_f32 v97, v97
  v_exp_f32 v100, v100
  v_exp_f32 v101, v101
  v_exp_f32 v104, v104
  v_exp_f32 v105, v105
  v_exp_f32 v108, v108
  v_exp_f32 v109, v109
  v_pk_add_f32 v[96:97], v[96:97], 1.0 op_sel_hi:[1,0]
  v_pk_add_f32 v[100:101], v[100:101], 1.0 op_sel_hi:[1,0]
  v_pk_add_f32 v[104:105], v[104:105], 1.0 op_sel_hi:[1,0]
  v_pk_add_f32 v[108:109], v[108:109], 1.0 op_sel_hi:[1,0]
  v_rcp_f32 v96, v96
  v_rcp_f32 v97, v97
  v_rcp_f32 v100, v100
  v_rcp_f32 v101, v101
  v_rcp_f32 v104, v104
  v_rcp_f32 v105, v105
  v_rcp_f32 v108, v108
  v_rcp_f32 v109, v109
  v_pk_mul_f32 v[160:161], v[160:161], v[96:97]
  v_pk_mul_f32 v[162:163], v[162:163], v[100:101]
  v_pk_mul_f32 v[176:177], v[176:177], v[104:105]
  v_pk_mul_f32 v[178:179], v[178:179], v[108:109]
  v_cvt_pk_bf16_f32 v116, v160, v161
  v_cvt_pk_bf16_f32 v117, v162, v163
  v_cvt_pk_bf16_f32 v118, v176, v177
  v_cvt_pk_bf16_f32 v119, v178, v179
  s_mov_b32 s44, 1024
  buffer_store_dwordx4 v[116:119], v5, s[16:19], s44 offen sc1
  ds_write_b128 v24, v[116:119] offset:1024
  v_pk_fma_f32 v[96:97], v[48:49], v[18:19], v[52:53] op_sel:[0,1,0] op_sel_hi:[1,1,1]
  v_pk_fma_f32 v[100:101], v[50:51], v[18:19], v[54:55] op_sel:[0,1,0] op_sel_hi:[1,1,1]
  v_pk_fma_f32 v[104:105], v[56:57], v[18:19], v[60:61] op_sel:[0,1,0] op_sel_hi:[1,1,1]
  v_pk_fma_f32 v[108:109], v[58:59], v[18:19], v[62:63] op_sel:[0,1,0] op_sel_hi:[1,1,1]
  v_pk_fma_f32 v[164:165], v[164:165], v[18:19], v[96:97] op_sel_hi:[1,0,1]
  v_pk_fma_f32 v[166:167], v[166:167], v[18:19], v[100:101] op_sel_hi:[1,0,1]
  v_pk_fma_f32 v[180:181], v[180:181], v[18:19], v[104:105] op_sel_hi:[1,0,1]
  v_pk_fma_f32 v[182:183], v[182:183], v[18:19], v[108:109] op_sel_hi:[1,0,1]
  v_pk_mul_f32 v[96:97], v[164:165], v[164:165]
  v_pk_mul_f32 v[100:101], v[166:167], v[166:167]
  v_pk_mul_f32 v[104:105], v[180:181], v[180:181]
  v_pk_mul_f32 v[108:109], v[182:183], v[182:183]
  v_pk_fma_f32 v[96:97], v[96:97], s[52:53], v[112:113]
  v_pk_fma_f32 v[100:101], v[100:101], s[52:53], v[112:113]
  v_pk_fma_f32 v[104:105], v[104:105], s[52:53], v[112:113]
  v_pk_fma_f32 v[108:109], v[108:109], s[52:53], v[112:113]
  v_pk_mul_f32 v[96:97], v[96:97], v[164:165]
  v_pk_mul_f32 v[100:101], v[100:101], v[166:167]
  v_pk_mul_f32 v[104:105], v[104:105], v[180:181]
  v_pk_mul_f32 v[108:109], v[108:109], v[182:183]
  v_exp_f32 v96, v96
  v_exp_f32 v97, v97
  v_exp_f32 v100, v100
  v_exp_f32 v101, v101
  v_exp_f32 v104, v104
  v_exp_f32 v105, v105
  v_exp_f32 v108, v108
  v_exp_f32 v109, v109
  v_pk_add_f32 v[96:97], v[96:97], 1.0 op_sel_hi:[1,0]
  v_pk_add_f32 v[100:101], v[100:101], 1.0 op_sel_hi:[1,0]
  v_pk_add_f32 v[104:105], v[104:105], 1.0 op_sel_hi:[1,0]
  v_pk_add_f32 v[108:109], v[108:109], 1.0 op_sel_hi:[1,0]
  v_rcp_f32 v96, v96
  v_rcp_f32 v97, v97
  v_rcp_f32 v100, v100
  v_rcp_f32 v101, v101
  v_rcp_f32 v104, v104
  v_rcp_f32 v105, v105
  v_rcp_f32 v108, v108
  v_rcp_f32 v109, v109
  v_pk_mul_f32 v[164:165], v[164:165], v[96:97]
  v_pk_mul_f32 v[166:167], v[166:167], v[100:101]
  v_pk_mul_f32 v[180:181], v[180:181], v[104:105]
  v_pk_mul_f32 v[182:183], v[182:183], v[108:109]
  v_cvt_pk_bf16_f32 v120, v164, v165
  v_cvt_pk_bf16_f32 v121, v166, v167
  v_cvt_pk_bf16_f32 v122, v180, v181
  v_cvt_pk_bf16_f32 v123, v182, v183
  s_mov_b32 s44, 115712
  buffer_store_dwordx4 v[120:123], v5, s[16:19], s44 offen sc1
  ds_write_b128 v24, v[120:123] offset:3072
  v_pk_fma_f32 v[96:97], v[48:49], v[20:21], v[52:53] op_sel:[0,1,0] op_sel_hi:[1,1,1]
  v_pk_fma_f32 v[100:101], v[50:51], v[20:21], v[54:55] op_sel:[0,1,0] op_sel_hi:[1,1,1]
  v_pk_fma_f32 v[104:105], v[56:57], v[20:21], v[60:61] op_sel:[0,1,0] op_sel_hi:[1,1,1]
  v_pk_fma_f32 v[108:109], v[58:59], v[20:21], v[62:63] op_sel:[0,1,0] op_sel_hi:[1,1,1]
  v_pk_fma_f32 v[168:169], v[168:169], v[20:21], v[96:97] op_sel_hi:[1,0,1]
  v_pk_fma_f32 v[170:171], v[170:171], v[20:21], v[100:101] op_sel_hi:[1,0,1]
  v_pk_fma_f32 v[184:185], v[184:185], v[20:21], v[104:105] op_sel_hi:[1,0,1]
  v_pk_fma_f32 v[186:187], v[186:187], v[20:21], v[108:109] op_sel_hi:[1,0,1]
  v_pk_mul_f32 v[96:97], v[168:169], v[168:169]
  v_pk_mul_f32 v[100:101], v[170:171], v[170:171]
  v_pk_mul_f32 v[104:105], v[184:185], v[184:185]
  v_pk_mul_f32 v[108:109], v[186:187], v[186:187]
  v_pk_fma_f32 v[96:97], v[96:97], s[52:53], v[112:113]
  v_pk_fma_f32 v[100:101], v[100:101], s[52:53], v[112:113]
  v_pk_fma_f32 v[104:105], v[104:105], s[52:53], v[112:113]
  v_pk_fma_f32 v[108:109], v[108:109], s[52:53], v[112:113]
  v_pk_mul_f32 v[96:97], v[96:97], v[168:169]
  v_pk_mul_f32 v[100:101], v[100:101], v[170:171]
  v_pk_mul_f32 v[104:105], v[104:105], v[184:185]
  v_pk_mul_f32 v[108:109], v[108:109], v[186:187]
  v_exp_f32 v96, v96
  v_exp_f32 v97, v97
  v_exp_f32 v100, v100
  v_exp_f32 v101, v101
  v_exp_f32 v104, v104
  v_exp_f32 v105, v105
  v_exp_f32 v108, v108
  v_exp_f32 v109, v109
  v_pk_add_f32 v[96:97], v[96:97], 1.0 op_sel_hi:[1,0]
  v_pk_add_f32 v[100:101], v[100:101], 1.0 op_sel_hi:[1,0]
  v_pk_add_f32 v[104:105], v[104:105], 1.0 op_sel_hi:[1,0]
  v_pk_add_f32 v[108:109], v[108:109], 1.0 op_sel_hi:[1,0]
  v_rcp_f32 v96, v96
  v_rcp_f32 v97, v97
  v_rcp_f32 v100, v100
  v_rcp_f32 v101, v101
  v_rcp_f32 v104, v104
  v_rcp_f32 v105, v105
  v_rcp_f32 v108, v108
  v_rcp_f32 v109, v109
  v_pk_mul_f32 v[168:169], v[168:169], v[96:97]
  v_pk_mul_f32 v[170:171], v[170:171], v[100:101]
  v_pk_mul_f32 v[184:185], v[184:185], v[104:105]
  v_pk_mul_f32 v[186:187], v[186:187], v[108:109]
  v_cvt_pk_bf16_f32 v116, v168, v169
  v_cvt_pk_bf16_f32 v117, v170, v171
  v_cvt_pk_bf16_f32 v118, v184, v185
  v_cvt_pk_bf16_f32 v119, v186, v187
  s_mov_b32 s44, 230400
  buffer_store_dwordx4 v[116:119], v5, s[16:19], s44 offen sc1
  ds_write_b128 v24, v[116:119] offset:5120
  v_pk_fma_f32 v[96:97], v[48:49], v[22:23], v[52:53] op_sel:[0,1,0] op_sel_hi:[1,1,1]
  v_pk_fma_f32 v[100:101], v[50:51], v[22:23], v[54:55] op_sel:[0,1,0] op_sel_hi:[1,1,1]
  v_pk_fma_f32 v[104:105], v[56:57], v[22:23], v[60:61] op_sel:[0,1,0] op_sel_hi:[1,1,1]
  v_pk_fma_f32 v[108:109], v[58:59], v[22:23], v[62:63] op_sel:[0,1,0] op_sel_hi:[1,1,1]
  v_pk_fma_f32 v[172:173], v[172:173], v[22:23], v[96:97] op_sel_hi:[1,0,1]
  v_pk_fma_f32 v[174:175], v[174:175], v[22:23], v[100:101] op_sel_hi:[1,0,1]
  v_pk_fma_f32 v[188:189], v[188:189], v[22:23], v[104:105] op_sel_hi:[1,0,1]
  v_pk_fma_f32 v[190:191], v[190:191], v[22:23], v[108:109] op_sel_hi:[1,0,1]
  v_pk_mul_f32 v[96:97], v[172:173], v[172:173]
  v_pk_mul_f32 v[100:101], v[174:175], v[174:175]
  v_pk_mul_f32 v[104:105], v[188:189], v[188:189]
  v_pk_mul_f32 v[108:109], v[190:191], v[190:191]
  v_pk_fma_f32 v[96:97], v[96:97], s[52:53], v[112:113]
  v_pk_fma_f32 v[100:101], v[100:101], s[52:53], v[112:113]
  v_pk_fma_f32 v[104:105], v[104:105], s[52:53], v[112:113]
  v_pk_fma_f32 v[108:109], v[108:109], s[52:53], v[112:113]
  v_pk_mul_f32 v[96:97], v[96:97], v[172:173]
  v_pk_mul_f32 v[100:101], v[100:101], v[174:175]
  v_pk_mul_f32 v[104:105], v[104:105], v[188:189]
  v_pk_mul_f32 v[108:109], v[108:109], v[190:191]
  v_exp_f32 v96, v96
  v_exp_f32 v97, v97
  v_exp_f32 v100, v100
  v_exp_f32 v101, v101
  v_exp_f32 v104, v104
  v_exp_f32 v105, v105
  v_exp_f32 v108, v108
  v_exp_f32 v109, v109
  v_pk_add_f32 v[96:97], v[96:97], 1.0 op_sel_hi:[1,0]
  v_pk_add_f32 v[100:101], v[100:101], 1.0 op_sel_hi:[1,0]
  v_pk_add_f32 v[104:105], v[104:105], 1.0 op_sel_hi:[1,0]
  v_pk_add_f32 v[108:109], v[108:109], 1.0 op_sel_hi:[1,0]
  v_rcp_f32 v96, v96
  v_rcp_f32 v97, v97
  v_rcp_f32 v100, v100
  v_rcp_f32 v101, v101
  v_rcp_f32 v104, v104
  v_rcp_f32 v105, v105
  v_rcp_f32 v108, v108
  v_rcp_f32 v109, v109
  v_pk_mul_f32 v[172:173], v[172:173], v[96:97]
  v_pk_mul_f32 v[174:175], v[174:175], v[100:101]
  v_pk_mul_f32 v[188:189], v[188:189], v[104:105]
  v_pk_mul_f32 v[190:191], v[190:191], v[108:109]
  v_cvt_pk_bf16_f32 v120, v172, v173
  v_cvt_pk_bf16_f32 v121, v174, v175
  v_cvt_pk_bf16_f32 v122, v188, v189
  v_cvt_pk_bf16_f32 v123, v190, v191
  s_mov_b32 s44, 345088
  buffer_store_dwordx4 v[120:123], v5, s[16:19], s44 offen sc1
  ds_write_b128 v24, v[120:123] offset:7168
  v_pk_fma_f32 v[96:97], v[64:65], v[16:17], v[68:69] op_sel:[0,1,0] op_sel_hi:[1,1,1]
  v_pk_fma_f32 v[100:101], v[66:67], v[16:17], v[70:71] op_sel:[0,1,0] op_sel_hi:[1,1,1]
  v_pk_fma_f32 v[104:105], v[72:73], v[16:17], v[76:77] op_sel:[0,1,0] op_sel_hi:[1,1,1]
  v_pk_fma_f32 v[108:109], v[74:75], v[16:17], v[78:79] op_sel:[0,1,0] op_sel_hi:[1,1,1]
  v_pk_fma_f32 v[192:193], v[192:193], v[16:17], v[96:97] op_sel_hi:[1,0,1]
  v_pk_fma_f32 v[194:195], v[194:195], v[16:17], v[100:101] op_sel_hi:[1,0,1]
  v_pk_fma_f32 v[208:209], v[208:209], v[16:17], v[104:105] op_sel_hi:[1,0,1]
  v_pk_fma_f32 v[210:211], v[210:211], v[16:17], v[108:109] op_sel_hi:[1,0,1]
  v_pk_mul_f32 v[96:97], v[192:193], v[192:193]
  v_pk_mul_f32 v[100:101], v[194:195], v[194:195]
  v_pk_mul_f32 v[104:105], v[208:209], v[208:209]
  v_pk_mul_f32 v[108:109], v[210:211], v[210:211]
  v_pk_fma_f32 v[96:97], v[96:97], s[52:53], v[112:113]
  v_pk_fma_f32 v[100:101], v[100:101], s[52:53], v[112:113]
  v_pk_fma_f32 v[104:105], v[104:105], s[52:53], v[112:113]
  v_pk_fma_f32 v[108:109], v[108:109], s[52:53], v[112:113]
  v_pk_mul_f32 v[96:97], v[96:97], v[192:193]
  v_pk_mul_f32 v[100:101], v[100:101], v[194:195]
  v_pk_mul_f32 v[104:105], v[104:105], v[208:209]
  v_pk_mul_f32 v[108:109], v[108:109], v[210:211]
  v_exp_f32 v96, v96
  v_exp_f32 v97, v97
  v_exp_f32 v100, v100
  v_exp_f32 v101, v101
  v_exp_f32 v104, v104
  v_exp_f32 v105, v105
  v_exp_f32 v108, v108
  v_exp_f32 v109, v109
  v_pk_add_f32 v[96:97], v[96:97], 1.0 op_sel_hi:[1,0]
  v_pk_add_f32 v[100:101], v[100:101], 1.0 op_sel_hi:[1,0]
  v_pk_add_f32 v[104:105], v[104:105], 1.0 op_sel_hi:[1,0]
  v_pk_add_f32 v[108:109], v[108:109], 1.0 op_sel_hi:[1,0]
  v_rcp_f32 v96, v96
  v_rcp_f32 v97, v97
  v_rcp_f32 v100, v100
  v_rcp_f32 v101, v101
  v_rcp_f32 v104, v104
  v_rcp_f32 v105, v105
  v_rcp_f32 v108, v108
  v_rcp_f32 v109, v109
  v_pk_mul_f32 v[192:193], v[192:193], v[96:97]
  v_pk_mul_f32 v[194:195], v[194:195], v[100:101]
  v_pk_mul_f32 v[208:209], v[208:209], v[104:105]
  v_pk_mul_f32 v[210:211], v[210:211], v[108:109]
  v_cvt_pk_bf16_f32 v116, v192, v193
  v_cvt_pk_bf16_f32 v117, v194, v195
  v_cvt_pk_bf16_f32 v118, v208, v209
  v_cvt_pk_bf16_f32 v119, v210, v211
  s_mov_b32 s44, 2048
  buffer_store_dwordx4 v[116:119], v5, s[16:19], s44 offen sc1
  s_cmp_lg_u32 s49, 0
  s_cbranch_scc1 w1_nown0
  ds_write_b128 v24, v[116:119] offset:32768
  w1_nown0:
  v_pk_fma_f32 v[96:97], v[64:65], v[18:19], v[68:69] op_sel:[0,1,0] op_sel_hi:[1,1,1]
  v_pk_fma_f32 v[100:101], v[66:67], v[18:19], v[70:71] op_sel:[0,1,0] op_sel_hi:[1,1,1]
  v_pk_fma_f32 v[104:105], v[72:73], v[18:19], v[76:77] op_sel:[0,1,0] op_sel_hi:[1,1,1]
  v_pk_fma_f32 v[108:109], v[74:75], v[18:19], v[78:79] op_sel:[0,1,0] op_sel_hi:[1,1,1]
  v_pk_fma_f32 v[196:197], v[196:197], v[18:19], v[96:97] op_sel_hi:[1,0,1]
  v_pk_fma_f32 v[198:199], v[198:199], v[18:19], v[100:101] op_sel_hi:[1,0,1]
  v_pk_fma_f32 v[212:213], v[212:213], v[18:19], v[104:105] op_sel_hi:[1,0,1]
  v_pk_fma_f32 v[214:215], v[214:215], v[18:19], v[108:109] op_sel_hi:[1,0,1]
  v_pk_mul_f32 v[96:97], v[196:197], v[196:197]
  v_pk_mul_f32 v[100:101], v[198:199], v[198:199]
  v_pk_mul_f32 v[104:105], v[212:213], v[212:213]
  v_pk_mul_f32 v[108:109], v[214:215], v[214:215]
  v_pk_fma_f32 v[96:97], v[96:97], s[52:53], v[112:113]
  v_pk_fma_f32 v[100:101], v[100:101], s[52:53], v[112:113]
  v_pk_fma_f32 v[104:105], v[104:105], s[52:53], v[112:113]
  v_pk_fma_f32 v[108:109], v[108:109], s[52:53], v[112:113]
  v_pk_mul_f32 v[96:97], v[96:97], v[196:197]
  v_pk_mul_f32 v[100:101], v[100:101], v[198:199]
  v_pk_mul_f32 v[104:105], v[104:105], v[212:213]
  v_pk_mul_f32 v[108:109], v[108:109], v[214:215]
  v_exp_f32 v96, v96
  v_exp_f32 v97, v97
  v_exp_f32 v100, v100
  v_exp_f32 v101, v101
  v_exp_f32 v104, v104
  v_exp_f32 v105, v105
  v_exp_f32 v108, v108
  v_exp_f32 v109, v109
  v_pk_add_f32 v[96:97], v[96:97], 1.0 op_sel_hi:[1,0]
  v_pk_add_f32 v[100:101], v[100:101], 1.0 op_sel_hi:[1,0]
  v_pk_add_f32 v[104:105], v[104:105], 1.0 op_sel_hi:[1,0]
  v_pk_add_f32 v[108:109], v[108:109], 1.0 op_sel_hi:[1,0]
  v_rcp_f32 v96, v96
  v_rcp_f32 v97, v97
  v_rcp_f32 v100, v100
  v_rcp_f32 v101, v101
  v_rcp_f32 v104, v104
  v_rcp_f32 v105, v105
  v_rcp_f32 v108, v108
  v_rcp_f32 v109, v109
  v_pk_mul_f32 v[196:197], v[196:197], v[96:97]
  v_pk_mul_f32 v[198:199], v[198:199], v[100:101]
  v_pk_mul_f32 v[212:213], v[212:213], v[104:105]
  v_pk_mul_f32 v[214:215], v[214:215], v[108:109]
  v_cvt_pk_bf16_f32 v120, v196, v197
  v_cvt_pk_bf16_f32 v121, v198, v199
  v_cvt_pk_bf16_f32 v122, v212, v213
  v_cvt_pk_bf16_f32 v123, v214, v215
  s_mov_b32 s44, 116736
  buffer_store_dwordx4 v[120:123], v5, s[16:19], s44 offen sc1
  s_cmp_lg_u32 s49, 0
  s_cbranch_scc1 w1_nown1
  ds_write_b128 v24, v[120:123] offset:34816
  w1_nown1:
  v_pk_fma_f32 v[96:97], v[64:65], v[20:21], v[68:69] op_sel:[0,1,0] op_sel_hi:[1,1,1]
  v_pk_fma_f32 v[100:101], v[66:67], v[20:21], v[70:71] op_sel:[0,1,0] op_sel_hi:[1,1,1]
  v_pk_fma_f32 v[104:105], v[72:73], v[20:21], v[76:77] op_sel:[0,1,0] op_sel_hi:[1,1,1]
  v_pk_fma_f32 v[108:109], v[74:75], v[20:21], v[78:79] op_sel:[0,1,0] op_sel_hi:[1,1,1]
  v_pk_fma_f32 v[200:201], v[200:201], v[20:21], v[96:97] op_sel_hi:[1,0,1]
  v_pk_fma_f32 v[202:203], v[202:203], v[20:21], v[100:101] op_sel_hi:[1,0,1]
  v_pk_fma_f32 v[216:217], v[216:217], v[20:21], v[104:105] op_sel_hi:[1,0,1]
  v_pk_fma_f32 v[218:219], v[218:219], v[20:21], v[108:109] op_sel_hi:[1,0,1]
  v_pk_mul_f32 v[96:97], v[200:201], v[200:201]
  v_pk_mul_f32 v[100:101], v[202:203], v[202:203]
  v_pk_mul_f32 v[104:105], v[216:217], v[216:217]
  v_pk_mul_f32 v[108:109], v[218:219], v[218:219]
  v_pk_fma_f32 v[96:97], v[96:97], s[52:53], v[112:113]
  v_pk_fma_f32 v[100:101], v[100:101], s[52:53], v[112:113]
  v_pk_fma_f32 v[104:105], v[104:105], s[52:53], v[112:113]
  v_pk_fma_f32 v[108:109], v[108:109], s[52:53], v[112:113]
  v_pk_mul_f32 v[96:97], v[96:97], v[200:201]
  v_pk_mul_f32 v[100:101], v[100:101], v[202:203]
  v_pk_mul_f32 v[104:105], v[104:105], v[216:217]
  v_pk_mul_f32 v[108:109], v[108:109], v[218:219]
  v_exp_f32 v96, v96
  v_exp_f32 v97, v97
  v_exp_f32 v100, v100
  v_exp_f32 v101, v101
  v_exp_f32 v104, v104
  v_exp_f32 v105, v105
  v_exp_f32 v108, v108
  v_exp_f32 v109, v109
  v_pk_add_f32 v[96:97], v[96:97], 1.0 op_sel_hi:[1,0]
  v_pk_add_f32 v[100:101], v[100:101], 1.0 op_sel_hi:[1,0]
  v_pk_add_f32 v[104:105], v[104:105], 1.0 op_sel_hi:[1,0]
  v_pk_add_f32 v[108:109], v[108:109], 1.0 op_sel_hi:[1,0]
  v_rcp_f32 v96, v96
  v_rcp_f32 v97, v97
  v_rcp_f32 v100, v100
  v_rcp_f32 v101, v101
  v_rcp_f32 v104, v104
  v_rcp_f32 v105, v105
  v_rcp_f32 v108, v108
  v_rcp_f32 v109, v109
  v_pk_mul_f32 v[200:201], v[200:201], v[96:97]
  v_pk_mul_f32 v[202:203], v[202:203], v[100:101]
  v_pk_mul_f32 v[216:217], v[216:217], v[104:105]
  v_pk_mul_f32 v[218:219], v[218:219], v[108:109]
  v_cvt_pk_bf16_f32 v116, v200, v201
  v_cvt_pk_bf16_f32 v117, v202, v203
  v_cvt_pk_bf16_f32 v118, v216, v217
  v_cvt_pk_bf16_f32 v119, v218, v219
  s_mov_b32 s44, 231424
  buffer_store_dwordx4 v[116:119], v5, s[16:19], s44 offen sc1
  s_cmp_lg_u32 s49, 0
  s_cbranch_scc1 w1_nown2
  ds_write_b128 v24, v[116:119] offset:36864
  w1_nown2:
  v_pk_fma_f32 v[96:97], v[64:65], v[22:23], v[68:69] op_sel:[0,1,0] op_sel_hi:[1,1,1]
  v_pk_fma_f32 v[100:101], v[66:67], v[22:23], v[70:71] op_sel:[0,1,0] op_sel_hi:[1,1,1]
  v_pk_fma_f32 v[104:105], v[72:73], v[22:23], v[76:77] op_sel:[0,1,0] op_sel_hi:[1,1,1]
  v_pk_fma_f32 v[108:109], v[74:75], v[22:23], v[78:79] op_sel:[0,1,0] op_sel_hi:[1,1,1]
  v_pk_fma_f32 v[204:205], v[204:205], v[22:23], v[96:97] op_sel_hi:[1,0,1]
  v_pk_fma_f32 v[206:207], v[206:207], v[22:23], v[100:101] op_sel_hi:[1,0,1]
  v_pk_fma_f32 v[220:221], v[220:221], v[22:23], v[104:105] op_sel_hi:[1,0,1]
  v_pk_fma_f32 v[222:223], v[222:223], v[22:23], v[108:109] op_sel_hi:[1,0,1]
  v_pk_mul_f32 v[96:97], v[204:205], v[204:205]
  v_pk_mul_f32 v[100:101], v[206:207], v[206:207]
  v_pk_mul_f32 v[104:105], v[220:221], v[220:221]
  v_pk_mul_f32 v[108:109], v[222:223], v[222:223]
  v_pk_fma_f32 v[96:97], v[96:97], s[52:53], v[112:113]
  v_pk_fma_f32 v[100:101], v[100:101], s[52:53], v[112:113]
  v_pk_fma_f32 v[104:105], v[104:105], s[52:53], v[112:113]
  v_pk_fma_f32 v[108:109], v[108:109], s[52:53], v[112:113]
  v_pk_mul_f32 v[96:97], v[96:97], v[204:205]
  v_pk_mul_f32 v[100:101], v[100:101], v[206:207]
  v_pk_mul_f32 v[104:105], v[104:105], v[220:221]
  v_pk_mul_f32 v[108:109], v[108:109], v[222:223]
  v_exp_f32 v96, v96
  v_exp_f32 v97, v97
  v_exp_f32 v100, v100
  v_exp_f32 v101, v101
  v_exp_f32 v104, v104
  v_exp_f32 v105, v105
  v_exp_f32 v108, v108
  v_exp_f32 v109, v109
  v_pk_add_f32 v[96:97], v[96:97], 1.0 op_sel_hi:[1,0]
  v_pk_add_f32 v[100:101], v[100:101], 1.0 op_sel_hi:[1,0]
  v_pk_add_f32 v[104:105], v[104:105], 1.0 op_sel_hi:[1,0]
  v_pk_add_f32 v[108:109], v[108:109], 1.0 op_sel_hi:[1,0]
  v_rcp_f32 v96, v96
  v_rcp_f32 v97, v97
  v_rcp_f32 v100, v100
  v_rcp_f32 v101, v101
  v_rcp_f32 v104, v104
  v_rcp_f32 v105, v105
  v_rcp_f32 v108, v108
  v_rcp_f32 v109, v109
  v_pk_mul_f32 v[204:205], v[204:205], v[96:97]
  v_pk_mul_f32 v[206:207], v[206:207], v[100:101]
  v_pk_mul_f32 v[220:221], v[220:221], v[104:105]
  v_pk_mul_f32 v[222:223], v[222:223], v[108:109]
  v_cvt_pk_bf16_f32 v120, v204, v205
  v_cvt_pk_bf16_f32 v121, v206, v207
  v_cvt_pk_bf16_f32 v122, v220, v221
  v_cvt_pk_bf16_f32 v123, v222, v223
  s_mov_b32 s44, 346112
  buffer_store_dwordx4 v[120:123], v5, s[16:19], s44 offen sc1
  s_cmp_lg_u32 s49, 0
  s_cbranch_scc1 w1_nown3
  ds_write_b128 v24, v[120:123] offset:38912
  w1_nown3:
  s_waitcnt vmcnt(0) lgkmcnt(0)
  s_barrier
C_w2:
  s_load_dwordx2 s[16:17], s[0:1], 64
  s_load_dwordx2 s[20:21], s[0:1], 80
  s_load_dwordx2 s[24:25], s[0:1], 56
  s_load_dwordx2 s[28:29], s[0:1], 80
  s_bfe_u32 s36, s2, 0x10002
  s_and_b32 s37, s2, 1
  s_lshl_b32 s37, s37, 3
  s_bfe_u32 s43, s2, 0x30003
  s_add_u32 s37, s37, s43
  s_bfe_u32 s38, s2, 0x10001
  s_lshl_b32 s38, s38, 2
  s_lshr_b32 s43, s2, 6
  s_add_u32 s38, s38, s43
  s_lshr_b32 s43, s3, 1
  s_mul_i32 s43, s43, 8192
  v_lshl_add_u32 v8, v0, 4, s43
  v_lshrrev_b32 v1, 4, v0
  v_mul_u32_u24 v9, 1024, v1
  v_bfe_u32 v1, v0, 2, 2
  v_lshl_add_u32 v9, v1, 6, v9
  v_and_b32 v1, 3, v0
  v_lshl_add_u32 v9, v1, 3, v9
  v_add_u32 v9, 16384, v9
  v_bfe_u32 v1, v0, 4, 1
  v_lshlrev_b32 v1, 5, v1
  s_and_b32 s43, s3, 1
  s_mul_i32 s44, s43, 512
  v_xor_b32 v2, 32, v1
  v_add3_u32 v10, v9, v2, s44
  v_add3_u32 v9, v9, v1, s44
  s_mul_i32 s44, s36, 4096
  s_sub_u32 s45, 4096, s44
  v_add_u32 v11, s45, v8
  v_add_u32 v8, s44, v8
  v_mov_b32 v32, 0
  v_mov_b32 v33, 0
  v_mov_b32 v34, 0
  v_mov_b32 v35, 0
  s_nop 1
  v_mfma_f32_32x32x16_bf16 v[128:143], v[32:35], v[32:35], 0
  v_mfma_f32_32x32x16_bf16 v[144:159], v[32:35], v[32:35], 0
  v_mfma_f32_32x32x16_bf16 v[160:175], v[32:35], v[32:35], 0
  v_mfma_f32_32x32x16_bf16 v[176:191], v[32:35], v[32:35], 0
  s_waitcnt lgkmcnt(0)
  s_mov_b32 s18, 4194304
  s_mov_b32 s19, 0x00020000
  s_add_u32 s20, s20, 20971520
  s_addc_u32 s21, s21, 0
  s_mov_b32 s22, 4194304
  s_mov_b32 s23, 0x00020000
  s_mov_b32 s26, 2048
  s_mov_b32 s27, 0x00020000
  s_add_u32 s28, s28, 46137344
  s_addc_u32 s29, s29, 0
  s_mov_b32 s30, 8388608
  s_mov_b32 s31, 0x00020000
  s_lshl_b32 s43, s37, 3
  s_and_b32 s44, s3, 2
  s_lshl_b32 s44, s44, 1
  s_add_u32 s43, s43, s44
  s_lshl_b32 s44, s36, 1
  s_add_u32 s43, s43, s44
  s_lshl_b32 s43, s43, 5
  s_lshl_b32 s44, s38, 2
  s_add_u32 s43, s43, s44
  s_and_b32 s44, s3, 1
  s_lshl_b32 s44, s44, 1
  s_add_u32 s43, s43, s44
  s_lshl_b32 s43, s43, 10
  v_lshl_add_u32 v18, v0, 4, s43
  s_mov_b32 s44, 0
  buffer_load_dwordx4 v[96:99], v18, s[20:23], s44 offen offset:0
  s_mov_b32 s44, 0
  buffer_load_dwordx4 v[100:103], v18, s[20:23], s44 offen offset:1024
  s_mov_b32 s44, 32768
  buffer_load_dwordx4 v[104:107], v18, s[20:23], s44 offen offset:0
  s_mov_b32 s44, 32768
  buffer_load_dwordx4 v[108:111], v18, s[20:23], s44 offen offset:1024
  s_lshl_b32 s43, s38, 8
  s_and_b32 s44, s3, 1
  s_lshl_b32 s44, s44, 7
  s_add_u32 s43, s43, s44
  v_lshrrev_b32 v19, 4, v0
  v_lshl_add_u32 v19, v19, 3, s43
  buffer_load_dwordx2 v[112:113], v19, s[24:27], 0 offen offset:0
  buffer_load_dwordx2 v[114:115], v19, s[24:27], 0 offen offset:32
  buffer_load_dwordx2 v[116:117], v19, s[24:27], 0 offen offset:64
  buffer_load_dwordx2 v[118:119], v19, s[24:27], 0 offen offset:96
  s_mov_b32 s39, 0
  s_barrier
  v_add_u32 v12, s39, v8
  v_add_u32 v13, s39, v9
  v_add_u32 v14, s39, v10
  v_add_u32 v15, s39, v11
  s_add_u32 s39, s39, 32768
  s_cmp_eq_u32 s39, 131072
  s_cselect_b32 s39, 0, s39
  ds_read_b128 v[32:35], v12 offset:0
  ds_read_b128 v[36:39], v12 offset:2048
  ds_read_b128 v[40:43], v15 offset:0
  ds_read_b128 v[44:47], v15 offset:2048
  ds_read_b64_tr_b16 v[48:49], v13 offset:0
  ds_read_b64_tr_b16 v[50:51], v13 offset:4096
  ds_read_b64_tr_b16 v[52:53], v14 offset:0
  ds_read_b64_tr_b16 v[54:55], v14 offset:4096
  ds_read_b64_tr_b16 v[56:57], v13 offset:256
  ds_read_b64_tr_b16 v[58:59], v13 offset:4352
  ds_read_b64_tr_b16 v[60:61], v14 offset:256
  ds_read_b64_tr_b16 v[62:63], v14 offset:4352
  s_mov_b32 s40, 14
  s_branch w2_c1
.p2align 6
w2_cloop:
  s_waitcnt lgkmcnt(0)
  s_barrier
  v_mfma_f32_16x16x32_bf16 v[128:131], v[80:83], v[64:67], v[128:131]
  ds_read_b128 v[32:35], v12 offset:0
  v_mfma_f32_16x16x32_bf16 v[132:135], v[80:83], v[68:71], v[132:135]
  ds_read_b128 v[36:39], v12 offset:2048
  v_mfma_f32_16x16x32_bf16 v[136:139], v[80:83], v[72:75], v[136:139]
  ds_read_b128 v[40:43], v15 offset:0
  v_mfma_f32_16x16x32_bf16 v[140:143], v[80:83], v[76:79], v[140:143]
  ds_read_b128 v[44:47], v15 offset:2048
  v_mfma_f32_16x16x32_bf16 v[144:147], v[84:87], v[64:67], v[144:147]
  ds_read_b64_tr_b16 v[48:49], v13 offset:0
  v_mfma_f32_16x16x32_bf16 v[148:151], v[84:87], v[68:71], v[148:151]
  ds_read_b64_tr_b16 v[50:51], v13 offset:4096
  v_mfma_f32_16x16x32_bf16 v[152:155], v[84:87], v[72:75], v[152:155]
  ds_read_b64_tr_b16 v[52:53], v14 offset:0
  v_mfma_f32_16x16x32_bf16 v[156:159], v[84:87], v[76:79], v[156:159]
  ds_read_b64_tr_b16 v[54:55], v14 offset:4096
  v_mfma_f32_16x16x32_bf16 v[160:163], v[88:91], v[64:67], v[160:163]
  ds_read_b64_tr_b16 v[56:57], v13 offset:256
  v_mfma_f32_16x16x32_bf16 v[164:167], v[88:91], v[68:71], v[164:167]
  ds_read_b64_tr_b16 v[58:59], v13 offset:4352
  v_mfma_f32_16x16x32_bf16 v[168:171], v[88:91], v[72:75], v[168:171]
  ds_read_b64_tr_b16 v[60:61], v14 offset:256
  v_mfma_f32_16x16x32_bf16 v[172:175], v[88:91], v[76:79], v[172:175]
  ds_read_b64_tr_b16 v[62:63], v14 offset:4352
  v_mfma_f32_16x16x32_bf16 v[176:179], v[92:95], v[64:67], v[176:179]
  v_mfma_f32_16x16x32_bf16 v[180:183], v[92:95], v[68:71], v[180:183]
  v_mfma_f32_16x16x32_bf16 v[184:187], v[92:95], v[72:75], v[184:187]
  v_mfma_f32_16x16x32_bf16 v[188:191], v[92:95], v[76:79], v[188:191]
w2_c1:
  s_waitcnt lgkmcnt(0)
  v_mfma_f32_16x16x32_bf16 v[128:131], v[48:51], v[32:35], v[128:131]
  ds_read_b128 v[64:67], v12 offset:1024
  v_mfma_f32_16x16x32_bf16 v[132:135], v[48:51], v[36:39], v[132:135]
  ds_read_b128 v[68:71], v12 offset:3072
  v_mfma_f32_16x16x32_bf16 v[136:139], v[48:51], v[40:43], v[136:139]
  ds_read_b128 v[72:75], v15 offset:1024
  v_mfma_f32_16x16x32_bf16 v[140:143], v[48:51], v[44:47], v[140:143]
  ds_read_b128 v[76:79], v15 offset:3072
  v_mfma_f32_16x16x32_bf16 v[144:147], v[52:55], v[32:35], v[144:147]
  ds_read_b64_tr_b16 v[80:81], v13 offset:8192
  v_mfma_f32_16x16x32_bf16 v[148:151], v[52:55], v[36:39], v[148:151]
  ds_read_b64_tr_b16 v[82:83], v13 offset:12288
  v_mfma_f32_16x16x32_bf16 v[152:155], v[52:55], v[40:43], v[152:155]
  ds_read_b64_tr_b16 v[84:85], v14 offset:8192
  v_mfma_f32_16x16x32_bf16 v[156:159], v[52:55], v[44:47], v[156:159]
  ds_read_b64_tr_b16 v[86:87], v14 offset:12288
  v_mfma_f32_16x16x32_bf16 v[160:163], v[56:59], v[32:35], v[160:163]
  ds_read_b64_tr_b16 v[88:89], v13 offset:8448
  v_mfma_f32_16x16x32_bf16 v[164:167], v[56:59], v[36:39], v[164:167]
  ds_read_b64_tr_b16 v[90:91], v13 offset:12544
  v_mfma_f32_16x16x32_bf16 v[168:171], v[56:59], v[40:43], v[168:171]
  ds_read_b64_tr_b16 v[92:93], v14 offset:8448
  v_mfma_f32_16x16x32_bf16 v[172:175], v[56:59], v[44:47], v[172:175]
  ds_read_b64_tr_b16 v[94:95], v14 offset:12544
  v_mfma_f32_16x16x32_bf16 v[176:179], v[60:63], v[32:35], v[176:179]
  v_add_u32 v16, s39, v8
  v_mfma_f32_16x16x32_bf16 v[180:183], v[60:63], v[36:39], v[180:183]
  v_add_u32 v17, s39, v9
  v_mfma_f32_16x16x32_bf16 v[184:187], v[60:63], v[40:43], v[184:187]
  v_add_u32 v18, s39, v10
  v_mfma_f32_16x16x32_bf16 v[188:191], v[60:63], v[44:47], v[188:191]
  v_add_u32 v19, s39, v11
  s_add_u32 s39, s39, 32768
  s_cmp_eq_u32 s39, 131072
  s_cselect_b32 s39, 0, s39
  s_waitcnt lgkmcnt(0)
  s_barrier
  v_mfma_f32_16x16x32_bf16 v[128:131], v[80:83], v[64:67], v[128:131]
  ds_read_b128 v[32:35], v16 offset:0
  v_mfma_f32_16x16x32_bf16 v[132:135], v[80:83], v[68:71], v[132:135]
  ds_read_b128 v[36:39], v16 offset:2048
  v_mfma_f32_16x16x32_bf16 v[136:139], v[80:83], v[72:75], v[136:139]
  ds_read_b128 v[40:43], v19 offset:0
  v_mfma_f32_16x16x32_bf16 v[140:143], v[80:83], v[76:79], v[140:143]
  ds_read_b128 v[44:47], v19 offset:2048
  v_mfma_f32_16x16x32_bf16 v[144:147], v[84:87], v[64:67], v[144:147]
  ds_read_b64_tr_b16 v[48:49], v17 offset:0
  v_mfma_f32_16x16x32_bf16 v[148:151], v[84:87], v[68:71], v[148:151]
  ds_read_b64_tr_b16 v[50:51], v17 offset:4096
  v_mfma_f32_16x16x32_bf16 v[152:155], v[84:87], v[72:75], v[152:155]
  ds_read_b64_tr_b16 v[52:53], v18 offset:0
  v_mfma_f32_16x16x32_bf16 v[156:159], v[84:87], v[76:79], v[156:159]
  ds_read_b64_tr_b16 v[54:55], v18 offset:4096
  v_mfma_f32_16x16x32_bf16 v[160:163], v[88:91], v[64:67], v[160:163]
  ds_read_b64_tr_b16 v[56:57], v17 offset:256
  v_mfma_f32_16x16x32_bf16 v[164:167], v[88:91], v[68:71], v[164:167]
  ds_read_b64_tr_b16 v[58:59], v17 offset:4352
  v_mfma_f32_16x16x32_bf16 v[168:171], v[88:91], v[72:75], v[168:171]
  ds_read_b64_tr_b16 v[60:61], v18 offset:256
  v_mfma_f32_16x16x32_bf16 v[172:175], v[88:91], v[76:79], v[172:175]
  ds_read_b64_tr_b16 v[62:63], v18 offset:4352
  v_mfma_f32_16x16x32_bf16 v[176:179], v[92:95], v[64:67], v[176:179]
  v_mfma_f32_16x16x32_bf16 v[180:183], v[92:95], v[68:71], v[180:183]
  v_mfma_f32_16x16x32_bf16 v[184:187], v[92:95], v[72:75], v[184:187]
  v_mfma_f32_16x16x32_bf16 v[188:191], v[92:95], v[76:79], v[188:191]
  s_waitcnt lgkmcnt(0)
  v_mfma_f32_16x16x32_bf16 v[128:131], v[48:51], v[32:35], v[128:131]
  ds_read_b128 v[64:67], v16 offset:1024
  v_mfma_f32_16x16x32_bf16 v[132:135], v[48:51], v[36:39], v[132:135]
  ds_read_b128 v[68:71], v16 offset:3072
  v_mfma_f32_16x16x32_bf16 v[136:139], v[48:51], v[40:43], v[136:139]
  ds_read_b128 v[72:75], v19 offset:1024
  v_mfma_f32_16x16x32_bf16 v[140:143], v[48:51], v[44:47], v[140:143]
  ds_read_b128 v[76:79], v19 offset:3072
  v_mfma_f32_16x16x32_bf16 v[144:147], v[52:55], v[32:35], v[144:147]
  ds_read_b64_tr_b16 v[80:81], v17 offset:8192
  v_mfma_f32_16x16x32_bf16 v[148:151], v[52:55], v[36:39], v[148:151]
  ds_read_b64_tr_b16 v[82:83], v17 offset:12288
  v_mfma_f32_16x16x32_bf16 v[152:155], v[52:55], v[40:43], v[152:155]
  ds_read_b64_tr_b16 v[84:85], v18 offset:8192
  v_mfma_f32_16x16x32_bf16 v[156:159], v[52:55], v[44:47], v[156:159]
  ds_read_b64_tr_b16 v[86:87], v18 offset:12288
  v_mfma_f32_16x16x32_bf16 v[160:163], v[56:59], v[32:35], v[160:163]
  ds_read_b64_tr_b16 v[88:89], v17 offset:8448
  v_mfma_f32_16x16x32_bf16 v[164:167], v[56:59], v[36:39], v[164:167]
  ds_read_b64_tr_b16 v[90:91], v17 offset:12544
  v_mfma_f32_16x16x32_bf16 v[168:171], v[56:59], v[40:43], v[168:171]
  ds_read_b64_tr_b16 v[92:93], v18 offset:8448
  v_mfma_f32_16x16x32_bf16 v[172:175], v[56:59], v[44:47], v[172:175]
  ds_read_b64_tr_b16 v[94:95], v18 offset:12544
  v_mfma_f32_16x16x32_bf16 v[176:179], v[60:63], v[32:35], v[176:179]
  v_add_u32 v12, s39, v8
  v_mfma_f32_16x16x32_bf16 v[180:183], v[60:63], v[36:39], v[180:183]
  v_add_u32 v13, s39, v9
  v_mfma_f32_16x16x32_bf16 v[184:187], v[60:63], v[40:43], v[184:187]
  v_add_u32 v14, s39, v10
  v_mfma_f32_16x16x32_bf16 v[188:191], v[60:63], v[44:47], v[188:191]
  v_add_u32 v15, s39, v11
  s_add_u32 s39, s39, 32768
  s_cmp_eq_u32 s39, 131072
  s_cselect_b32 s39, 0, s39
  s_sub_u32 s40, s40, 1
  s_cmp_lg_u32 s40, 0
  s_cbranch_scc1 w2_cloop
  s_waitcnt lgkmcnt(0)
  v_mfma_f32_16x16x32_bf16 v[128:131], v[80:83], v[64:67], v[128:131]
  v_mfma_f32_16x16x32_bf16 v[132:135], v[80:83], v[68:71], v[132:135]
  v_mfma_f32_16x16x32_bf16 v[136:139], v[80:83], v[72:75], v[136:139]
  v_mfma_f32_16x16x32_bf16 v[140:143], v[80:83], v[76:79], v[140:143]
  v_mfma_f32_16x16x32_bf16 v[144:147], v[84:87], v[64:67], v[144:147]
  v_mfma_f32_16x16x32_bf16 v[148:151], v[84:87], v[68:71], v[148:151]
  v_mfma_f32_16x16x32_bf16 v[152:155], v[84:87], v[72:75], v[152:155]
  v_mfma_f32_16x16x32_bf16 v[156:159], v[84:87], v[76:79], v[156:159]
  v_mfma_f32_16x16x32_bf16 v[160:163], v[88:91], v[64:67], v[160:163]
  v_mfma_f32_16x16x32_bf16 v[164:167], v[88:91], v[68:71], v[164:167]
  v_mfma_f32_16x16x32_bf16 v[168:171], v[88:91], v[72:75], v[168:171]
  v_mfma_f32_16x16x32_bf16 v[172:175], v[88:91], v[76:79], v[172:175]
  v_mfma_f32_16x16x32_bf16 v[176:179], v[92:95], v[64:67], v[176:179]
  v_mfma_f32_16x16x32_bf16 v[180:183], v[92:95], v[68:71], v[180:183]
  v_mfma_f32_16x16x32_bf16 v[184:187], v[92:95], v[72:75], v[184:187]
  v_mfma_f32_16x16x32_bf16 v[188:191], v[92:95], v[76:79], v[188:191]
  s_nop 7
  s_lshl_b32 s43, s37, 3
  s_add_u32 s43, s43, s38
  s_lshl_b32 s43, s43, 1
  s_add_u32 s44, s43, s36
  s_xor_b32 s45, s44, 1
  s_lshl_b32 s44, s44, 15
  s_lshl_b32 s45, s45, 15
  s_lshl_b32 s43, s3, 13
  s_add_u32 s44, s44, s43
  s_add_u32 s45, s45, s43
  v_lshl_add_u32 v20, v0, 4, s45
  v_lshl_add_u32 v21, v0, 4, s44
  v_cvt_pk_bf16_f32 v32, v136, v137
  v_cvt_pk_bf16_f32 v33, v138, v139
  v_cvt_pk_bf16_f32 v34, v152, v153
  v_mov_b32 v35, s33
  s_mov_b32 s43, 0
  buffer_store_dwordx4 v[32:35], v20, s[28:31], s43 offen offset:0 sc1
  v_cvt_pk_bf16_f32 v36, v154, v155
  v_cvt_pk_bf16_f32 v37, v168, v169
  v_cvt_pk_bf16_f32 v38, v170, v171
  v_mov_b32 v39, s33
  s_mov_b32 s43, 0
  buffer_store_dwordx4 v[36:39], v20, s[28:31], s43 offen offset:1024 sc1
  v_cvt_pk_bf16_f32 v40, v184, v185
  v_cvt_pk_bf16_f32 v41, v186, v187
  v_cvt_pk_bf16_f32 v42, v140, v141
  v_mov_b32 v43, s33
  s_mov_b32 s43, 0
  buffer_store_dwordx4 v[40:43], v20, s[28:31], s43 offen offset:2048 sc1
  v_cvt_pk_bf16_f32 v44, v142, v143
  v_cvt_pk_bf16_f32 v45, v156, v157
  v_cvt_pk_bf16_f32 v46, v158, v159
  v_mov_b32 v47, s33
  s_mov_b32 s43, 0
  buffer_store_dwordx4 v[44:47], v20, s[28:31], s43 offen offset:3072 sc1
  v_cvt_pk_bf16_f32 v48, v172, v173
  v_cvt_pk_bf16_f32 v49, v174, v175
  v_cvt_pk_bf16_f32 v50, v188, v189
  v_mov_b32 v51, s33
  s_mov_b32 s43, 4096
  buffer_store_dwordx4 v[48:51], v20, s[28:31], s43 offen offset:0 sc1
  v_cvt_pk_bf16_f32 v52, v190, v191
  v_mov_b32 v55, s33
  s_mov_b32 s43, 4096
  buffer_store_dwordx4 v[52:55], v20, s[28:31], s43 offen offset:1024 sc1
  s_lshr_b32 s43, s3, 1
  s_lshl_b32 s43, s43, 13
  s_add_u32 s43, s43, 131072
  s_and_b32 s44, s3, 1
  s_lshl_b32 s44, s44, 3
  v_and_b32 v1, 15, v0
  v_lshrrev_b32 v4, 5, v0
  v_add_u32 v4, s44, v4
  v_xor_b32 v4, v4, v1
  v_lshlrev_b32 v4, 4, v4
  v_lshl_add_u32 v4, v1, 8, v4
  v_bfe_u32 v1, v0, 4, 1
  v_lshl_add_u32 v4, v1, 3, v4
  v_add_u32 v16, s43, v4
  s_waitcnt vmcnt(6)
  v_lshlrev_b32 v64, 16, v112
  v_and_b32 v65, 0xffff0000, v112
  v_lshlrev_b32 v66, 16, v113
  v_and_b32 v67, 0xffff0000, v113
  v_lshlrev_b32 v68, 16, v114
  v_and_b32 v69, 0xffff0000, v114
  v_lshlrev_b32 v70, 16, v115
  v_and_b32 v71, 0xffff0000, v115
  v_lshlrev_b32 v72, 16, v116
  v_and_b32 v73, 0xffff0000, v116
  v_lshlrev_b32 v74, 16, v117
  v_and_b32 v75, 0xffff0000, v117
  v_lshlrev_b32 v76, 16, v118
  v_and_b32 v77, 0xffff0000, v118
  v_lshlrev_b32 v78, 16, v119
  v_and_b32 v79, 0xffff0000, v119
  v_lshlrev_b32 v22, 16, v96
  v_and_b32 v23, 0xffff0000, v96
  v_lshlrev_b32 v24, 16, v97
  v_and_b32 v25, 0xffff0000, v97
  v_pk_add_f32 v[128:129], v[128:129], v[64:65]
  v_pk_add_f32 v[130:131], v[130:131], v[66:67]
  v_pk_add_f32 v[128:129], v[128:129], v[22:23]
  v_pk_add_f32 v[130:131], v[130:131], v[24:25]
  v_lshlrev_b32 v22, 16, v98
  v_and_b32 v23, 0xffff0000, v98
  v_lshlrev_b32 v24, 16, v99
  v_and_b32 v25, 0xffff0000, v99
  v_pk_add_f32 v[144:145], v[144:145], v[68:69]
  v_pk_add_f32 v[146:147], v[146:147], v[70:71]
  v_pk_add_f32 v[144:145], v[144:145], v[22:23]
  v_pk_add_f32 v[146:147], v[146:147], v[24:25]
  v_lshlrev_b32 v22, 16, v100
  v_and_b32 v23, 0xffff0000, v100
  v_lshlrev_b32 v24, 16, v101
  v_and_b32 v25, 0xffff0000, v101
  v_pk_add_f32 v[160:161], v[160:161], v[72:73]
  v_pk_add_f32 v[162:163], v[162:163], v[74:75]
  v_pk_add_f32 v[160:161], v[160:161], v[22:23]
  v_pk_add_f32 v[162:163], v[162:163], v[24:25]
  v_lshlrev_b32 v22, 16, v102
  v_and_b32 v23, 0xffff0000, v102
  v_lshlrev_b32 v24, 16, v103
  v_and_b32 v25, 0xffff0000, v103
  v_pk_add_f32 v[176:177], v[176:177], v[76:77]
  v_pk_add_f32 v[178:179], v[178:179], v[78:79]
  v_pk_add_f32 v[176:177], v[176:177], v[22:23]
  v_pk_add_f32 v[178:179], v[178:179], v[24:25]
  v_lshlrev_b32 v22, 16, v104
  v_and_b32 v23, 0xffff0000, v104
  v_lshlrev_b32 v24, 16, v105
  v_and_b32 v25, 0xffff0000, v105
  v_pk_add_f32 v[132:133], v[132:133], v[64:65]
  v_pk_add_f32 v[134:135], v[134:135], v[66:67]
  v_pk_add_f32 v[132:133], v[132:133], v[22:23]
  v_pk_add_f32 v[134:135], v[134:135], v[24:25]
  v_lshlrev_b32 v22, 16, v106
  v_and_b32 v23, 0xffff0000, v106
  v_lshlrev_b32 v24, 16, v107
  v_and_b32 v25, 0xffff0000, v107
  v_pk_add_f32 v[148:149], v[148:149], v[68:69]
  v_pk_add_f32 v[150:151], v[150:151], v[70:71]
  v_pk_add_f32 v[148:149], v[148:149], v[22:23]
  v_pk_add_f32 v[150:151], v[150:151], v[24:25]
  v_lshlrev_b32 v22, 16, v108
  v_and_b32 v23, 0xffff0000, v108
  v_lshlrev_b32 v24, 16, v109
  v_and_b32 v25, 0xffff0000, v109
  v_pk_add_f32 v[164:165], v[164:165], v[72:73]
  v_pk_add_f32 v[166:167], v[166:167], v[74:75]
  v_pk_add_f32 v[164:165], v[164:165], v[22:23]
  v_pk_add_f32 v[166:167], v[166:167], v[24:25]
  v_lshlrev_b32 v22, 16, v110
  v_and_b32 v23, 0xffff0000, v110
  v_lshlrev_b32 v24, 16, v111
  v_and_b32 v25, 0xffff0000, v111
  v_pk_add_f32 v[180:181], v[180:181], v[76:77]
  v_pk_add_f32 v[182:183], v[182:183], v[78:79]
  v_pk_add_f32 v[180:181], v[180:181], v[22:23]
  v_pk_add_f32 v[182:183], v[182:183], v[24:25]
  s_waitcnt vmcnt(0)
  s_mov_b32 s45, 0x8000
w2_xp:
  s_mov_b32 s43, 0
  buffer_load_dwordx4 v[200:203], v21, s[28:31], s43 offen offset:0 sc1
  s_mov_b32 s43, 0
  buffer_load_dwordx4 v[204:207], v21, s[28:31], s43 offen offset:1024 sc1
  s_mov_b32 s43, 0
  buffer_load_dwordx4 v[208:211], v21, s[28:31], s43 offen offset:2048 sc1
  s_mov_b32 s43, 0
  buffer_load_dwordx4 v[212:215], v21, s[28:31], s43 offen offset:3072 sc1
  s_mov_b32 s43, 4096
  buffer_load_dwordx4 v[216:219], v21, s[28:31], s43 offen offset:0 sc1
  s_mov_b32 s43, 4096
  buffer_load_dwordx4 v[220:223], v21, s[28:31], s43 offen offset:1024 sc1
  s_sub_u32 s45, s45, 1
  s_cmp_eq_u32 s45, 0
  s_cbranch_scc1 w2_xp_x
  s_waitcnt vmcnt(0)
  v_xor_b32 v2, s33, v203
  v_xor_b32 v3, s33, v207
  v_or_b32 v2, v2, v3
  v_xor_b32 v3, s33, v211
  v_or_b32 v2, v2, v3
  v_xor_b32 v3, s33, v215
  v_or_b32 v2, v2, v3
  v_xor_b32 v3, s33, v219
  v_or_b32 v2, v2, v3
  v_xor_b32 v3, s33, v223
  v_or_b32 v2, v2, v3
  v_cmp_ne_u32 vcc, 0, v2
  s_nop 4
  s_cbranch_vccnz w2_xp
w2_xp_x:
  s_waitcnt vmcnt(0)
  v_lshlrev_b32 v22, 16, v200
  v_and_b32 v23, 0xffff0000, v200
  v_lshlrev_b32 v24, 16, v201
  v_and_b32 v25, 0xffff0000, v201
  v_pk_add_f32 v[128:129], v[128:129], v[22:23]
  v_pk_add_f32 v[130:131], v[130:131], v[24:25]
  v_cvt_pk_bf16_f32 v80, v128, v129
  v_cvt_pk_bf16_f32 v81, v130, v131
  v_xor_b32 v26, 0, v16
  ds_write_b64 v26, v[80:81] offset:0
  v_lshlrev_b32 v22, 16, v202
  v_and_b32 v23, 0xffff0000, v202
  v_lshlrev_b32 v24, 16, v204
  v_and_b32 v25, 0xffff0000, v204
  v_pk_add_f32 v[144:145], v[144:145], v[22:23]
  v_pk_add_f32 v[146:147], v[146:147], v[24:25]
  v_cvt_pk_bf16_f32 v82, v144, v145
  v_cvt_pk_bf16_f32 v83, v146, v147
  v_xor_b32 v26, 32, v16
  ds_write_b64 v26, v[82:83] offset:0
  v_lshlrev_b32 v22, 16, v205
  v_and_b32 v23, 0xffff0000, v205
  v_lshlrev_b32 v24, 16, v206
  v_and_b32 v25, 0xffff0000, v206
  v_pk_add_f32 v[160:161], v[160:161], v[22:23]
  v_pk_add_f32 v[162:163], v[162:163], v[24:25]
  v_cvt_pk_bf16_f32 v84, v160, v161
  v_cvt_pk_bf16_f32 v85, v162, v163
  v_xor_b32 v26, 64, v16
  ds_write_b64 v26, v[84:85] offset:0
  v_lshlrev_b32 v22, 16, v208
  v_and_b32 v23, 0xffff0000, v208
  v_lshlrev_b32 v24, 16, v209
  v_and_b32 v25, 0xffff0000, v209
  v_pk_add_f32 v[176:177], v[176:177], v[22:23]
  v_pk_add_f32 v[178:179], v[178:179], v[24:25]
  v_cvt_pk_bf16_f32 v86, v176, v177
  v_cvt_pk_bf16_f32 v87, v178, v179
  v_xor_b32 v26, 96, v16
  ds_write_b64 v26, v[86:87] offset:0
  v_lshlrev_b32 v22, 16, v210
  v_and_b32 v23, 0xffff0000, v210
  v_lshlrev_b32 v24, 16, v212
  v_and_b32 v25, 0xffff0000, v212
  v_pk_add_f32 v[132:133], v[132:133], v[22:23]
  v_pk_add_f32 v[134:135], v[134:135], v[24:25]
  v_cvt_pk_bf16_f32 v80, v132, v133
  v_cvt_pk_bf16_f32 v81, v134, v135
  v_xor_b32 v26, 0, v16
  ds_write_b64 v26, v[80:81] offset:4096
  v_lshlrev_b32 v22, 16, v213
  v_and_b32 v23, 0xffff0000, v213
  v_lshlrev_b32 v24, 16, v214
  v_and_b32 v25, 0xffff0000, v214
  v_pk_add_f32 v[148:149], v[148:149], v[22:23]
  v_pk_add_f32 v[150:151], v[150:151], v[24:25]
  v_cvt_pk_bf16_f32 v82, v148, v149
  v_cvt_pk_bf16_f32 v83, v150, v151
  v_xor_b32 v26, 32, v16
  ds_write_b64 v26, v[82:83] offset:4096
  v_lshlrev_b32 v22, 16, v216
  v_and_b32 v23, 0xffff0000, v216
  v_lshlrev_b32 v24, 16, v217
  v_and_b32 v25, 0xffff0000, v217
  v_pk_add_f32 v[164:165], v[164:165], v[22:23]
  v_pk_add_f32 v[166:167], v[166:167], v[24:25]
  v_cvt_pk_bf16_f32 v84, v164, v165
  v_cvt_pk_bf16_f32 v85, v166, v167
  v_xor_b32 v26, 64, v16
  ds_write_b64 v26, v[84:85] offset:4096
  v_lshlrev_b32 v22, 16, v218
  v_and_b32 v23, 0xffff0000, v218
  v_lshlrev_b32 v24, 16, v220
  v_and_b32 v25, 0xffff0000, v220
  v_pk_add_f32 v[180:181], v[180:181], v[22:23]
  v_pk_add_f32 v[182:183], v[182:183], v[24:25]
  v_cvt_pk_bf16_f32 v86, v180, v181
  v_cvt_pk_bf16_f32 v87, v182, v183
  v_xor_b32 v26, 96, v16
  ds_write_b64 v26, v[86:87] offset:4096
  s_waitcnt lgkmcnt(0)
  s_barrier
  s_lshl_b32 s43, s3, 12
  s_add_u32 s43, s43, 131072
  v_lshl_add_u32 v1, v0, 4, s43
  ds_read_b128 v[32:35], v1 offset:0
  ds_read_b128 v[36:39], v1 offset:1024
  ds_read_b128 v[40:43], v1 offset:2048
  ds_read_b128 v[44:47], v1 offset:3072
  s_lshl_b32 s43, s37, 7
  s_and_b32 s44, s3, 2
  s_lshl_b32 s44, s44, 5
  s_add_u32 s43, s43, s44
  s_lshl_b32 s44, s36, 5
  s_add_u32 s43, s43, s44
  s_and_b32 s44, s3, 1
  s_lshl_b32 s44, s44, 4
  s_add_u32 s43, s43, s44
  s_lshl_b32 s43, s43, 11
  s_lshl_b32 s44, s38, 8
  s_add_u32 s43, s43, s44
  v_lshrrev_b32 v2, 4, v0
  v_and_b32 v4, 15, v0
  v_xor_b32 v3, v2, v4
  v_lshl_add_u32 v2, v2, 11, s43
  v_xor_b32 v4, 0, v3
  v_lshl_add_u32 v5, v4, 4, v2
  s_waitcnt lgkmcnt(3)
  s_mov_b32 s44, 0
  buffer_store_dwordx4 v[32:35], v5, s[16:19], s44 offen sc1
  v_xor_b32 v4, 4, v3
  v_lshl_add_u32 v6, v4, 4, v2
  s_waitcnt lgkmcnt(2)
  s_mov_b32 s44, 8192
  buffer_store_dwordx4 v[36:39], v6, s[16:19], s44 offen sc1
  v_xor_b32 v4, 8, v3
  v_lshl_add_u32 v7, v4, 4, v2
  s_waitcnt lgkmcnt(1)
  s_mov_b32 s44, 16384
  buffer_store_dwordx4 v[40:43], v7, s[16:19], s44 offen sc1
  v_xor_b32 v4, 12, v3
  v_lshl_add_u32 v8, v4, 4, v2
  s_waitcnt lgkmcnt(0)
  s_mov_b32 s44, 24576
  buffer_store_dwordx4 v[44:47], v8, s[16:19], s44 offen sc1
  s_endpgm
L_stream:
  s_cmp_lg_u32 s2, 0
  s_cbranch_scc1 L_nn
  s_cmp_lg_u32 s3, 7
  s_cbranch_scc1 L_nn
  s_memrealtime s[52:53]
  s_waitcnt lgkmcnt(0)
  s_or_b32 s52, s52, 1
  v_mov_b32 v3, s52
  v_mov_b32 v2, 0
  s_mov_b64 s[50:51], exec
  s_mov_b64 exec, 1
  global_store_dword v2, v3, s[54:55] sc1
  s_mov_b64 exec, s[50:51]
L_nn:
A_qkv:
  s_load_dwordx2 s[16:17], s[0:1], 80
  s_load_dwordx2 s[20:21], s[0:1], 80
  s_and_b32 s43, s2, 7
  s_lshr_b32 s44, s2, 3
  s_and_b32 s37, s43, 1
  s_mul_i32 s37, s37, 8
  s_and_b32 s45, s44, 7
  s_add_u32 s37, s37, s45
  s_lshr_b32 s38, s43, 1
  s_mul_i32 s38, s38, 4
  s_lshr_b32 s45, s44, 3
  s_add_u32 s38, s38, s45
  s_sub_u32 s46, s3, 6
  v_lshrrev_b32 v3, 5, v0
  v_and_b32 v4, 31, v0
  s_lshl_b32 s43, s46, 2
  v_add_u32 v5, s43, v3
  s_lshl_b32 s43, s2, 3
  v_add_u32 v6, s43, v5
  v_lshlrev_b32 v6, 11, v6
  v_lshl_add_u32 v6, v4, 4, v6
  v_min_u32 v7, 47, v0
  v_cmp_le_u32 vcc, 24, v7
  s_nop 1
  v_cndmask_b32 v9, 0, 1, vcc
  v_mul_u32_u24 v14, 24, v9
  v_sub_u32 v7, v7, v14
  s_lshl_b32 s43, s37, 6
  s_lshl_b32 s44, s46, 5
  s_add_u32 s43, s43, s44
  v_add_u32 v14, s43, v9
  v_mul_u32_u24 v14, 6144, v14
  v_lshrrev_b32 v15, 3, v7
  v_lshl_add_u32 v14, v15, 11, v14
  v_and_b32 v2, 7, v7
  v_lshl_add_u32 v14, v2, 4, v14
  s_lshl_b32 s43, s38, 7
  v_add_u32 v14, s43, v14
  s_waitcnt lgkmcnt(0)
  s_mov_b32 s10, 4194304
  s_mov_b32 s11, 0x00020000
  s_mov_b32 s14, 6291456
  s_mov_b32 s15, 0x00020000
  s_mov_b32 s43, 0
  buffer_load_dwordx4 v[16:19], v6, s[8:11], s43 offen offset:0
  buffer_load_dwordx4 v[20:23], v6, s[8:11], s43 offen offset:512
  buffer_load_dwordx4 v[24:27], v6, s[8:11], s43 offen offset:1024
  buffer_load_dwordx4 v[28:31], v6, s[8:11], s43 offen offset:1536
  s_mov_b32 s43, 4096
  buffer_load_dwordx4 v[32:35], v6, s[8:11], s43 offen offset:0
  buffer_load_dwordx4 v[36:39], v6, s[8:11], s43 offen offset:512
  buffer_load_dwordx4 v[40:43], v6, s[8:11], s43 offen offset:1024
  buffer_load_dwordx4 v[44:47], v6, s[8:11], s43 offen offset:1536
  s_mov_b32 s43, 0
  buffer_load_dwordx4 v[64:67], v14, s[12:15], s43 offen
  s_add_u32 s43, s43, 12288
  buffer_load_dwordx4 v[68:71], v14, s[12:15], s43 offen
  s_add_u32 s43, s43, 12288
  buffer_load_dwordx4 v[72:75], v14, s[12:15], s43 offen
  s_add_u32 s43, s43, 12288
  buffer_load_dwordx4 v[76:79], v14, s[12:15], s43 offen
  s_add_u32 s43, s43, 12288
  buffer_load_dwordx4 v[80:83], v14, s[12:15], s43 offen
  s_add_u32 s43, s43, 12288
  buffer_load_dwordx4 v[84:87], v14, s[12:15], s43 offen
  s_add_u32 s43, s43, 12288
  buffer_load_dwordx4 v[88:91], v14, s[12:15], s43 offen
  s_add_u32 s43, s43, 12288
  buffer_load_dwordx4 v[92:95], v14, s[12:15], s43 offen
  s_add_u32 s43, s43, 12288
  buffer_load_dwordx4 v[96:99], v14, s[12:15], s43 offen
  s_add_u32 s43, s43, 12288
  buffer_load_dwordx4 v[100:103], v14, s[12:15], s43 offen
  s_add_u32 s43, s43, 12288
  buffer_load_dwordx4 v[104:107], v14, s[12:15], s43 offen
  s_add_u32 s43, s43, 12288
  buffer_load_dwordx4 v[108:111], v14, s[12:15], s43 offen
  s_add_u32 s43, s43, 12288
  buffer_load_dwordx4 v[112:115], v14, s[12:15], s43 offen
  s_add_u32 s43, s43, 12288
  buffer_load_dwordx4 v[116:119], v14, s[12:15], s43 offen
  s_add_u32 s43, s43, 12288
  buffer_load_dwordx4 v[120:123], v14, s[12:15], s43 offen
  s_add_u32 s43, s43, 12288
  buffer_load_dwordx4 v[124:127], v14, s[12:15], s43 offen
  s_add_u32 s43, s43, 12288
  v_mov_b32 v48, 0
  global_load_dword v49, v48, s[54:55] sc1
  s_mov_b32 s18, 16384
  s_mov_b32 s19, 0x00020000
  s_add_u32 s20, s20, 65536
  s_addc_u32 s21, s21, 0
  s_mov_b32 s22, 196608
  s_mov_b32 s23, 0x00020000
  s_lshl_b32 s43, s46, 1
  v_add_u32 v9, s43, v9
  v_mul_u32_u24 v9, 768, v9
  v_lshrrev_b32 v63, 2, v2
  v_mul_u32_u24 v63, 3, v63
  v_add_u32 v63, v63, v15
  v_lshl_add_u32 v9, v63, 7, v9
  v_and_b32 v2, 3, v2
  v_lshl_add_u32 v9, v2, 5, v9
  v_add_u32 v9, 122880, v9
  v_lshlrev_b32 v7, 3, v5
  v_add_u32 v7, 129024, v7
  v_mov_b32 v8, 0x3f803f80
  s_barrier
  s_cmp_lg_u32 s3, 7
  s_cbranch_scc1 npf_q
  s_getpc_b64 s[52:53]
pc_q:
  s_sub_u32 s52, s52, pc_q-C_qkv
  s_subb_u32 s53, s53, 0
  v_lshlrev_b32 v240, 7, v0
  v_min_u32 v241, C_att-C_qkv-4, v240
  global_load_dword v242, v241, s[52:53]
npf_q:
  s_barrier
  s_waitcnt vmcnt(0)
  v_mov_b32 v10, 0
  v_mov_b32 v12, 0
  v_mov_b32 v11, 0
  v_mov_b32 v13, 0
  v_dot2_f32_bf16 v10, v16, v8, v10
  v_dot2_f32_bf16 v12, v16, v16, v12
  v_dot2_f32_bf16 v11, v17, v8, v11
  v_dot2_f32_bf16 v13, v17, v17, v13
  v_dot2_f32_bf16 v10, v18, v8, v10
  v_dot2_f32_bf16 v12, v18, v18, v12
  v_dot2_f32_bf16 v11, v19, v8, v11
  v_dot2_f32_bf16 v13, v19, v19, v13
  v_dot2_f32_bf16 v10, v20, v8, v10
  v_dot2_f32_bf16 v12, v20, v20, v12
  v_dot2_f32_bf16 v11, v21, v8, v11
  v_dot2_f32_bf16 v13, v21, v21, v13
  v_dot2_f32_bf16 v10, v22, v8, v10
  v_dot2_f32_bf16 v12, v22, v22, v12
  v_dot2_f32_bf16 v11, v23, v8, v11
  v_dot2_f32_bf16 v13, v23, v23, v13
  v_dot2_f32_bf16 v10, v24, v8, v10
  v_dot2_f32_bf16 v12, v24, v24, v12
  v_dot2_f32_bf16 v11, v25, v8, v11
  v_dot2_f32_bf16 v13, v25, v25, v13
  v_dot2_f32_bf16 v10, v26, v8, v10
  v_dot2_f32_bf16 v12, v26, v26, v12
  v_dot2_f32_bf16 v11, v27, v8, v11
  v_dot2_f32_bf16 v13, v27, v27, v13
  v_dot2_f32_bf16 v10, v28, v8, v10
  v_dot2_f32_bf16 v12, v28, v28, v12
  v_dot2_f32_bf16 v11, v29, v8, v11
  v_dot2_f32_bf16 v13, v29, v29, v13
  v_dot2_f32_bf16 v10, v30, v8, v10
  v_dot2_f32_bf16 v12, v30, v30, v12
  v_dot2_f32_bf16 v11, v31, v8, v11
  v_dot2_f32_bf16 v13, v31, v31, v13
  s_nop 2
  v_add_f32 v10, v10, v11
  v_add_f32 v12, v12, v13
  s_nop 0
  v_add_f32_dpp v10, v10, v10 quad_perm:[1,0,3,2] row_mask:0xf bank_mask:0xf
  v_add_f32_dpp v12, v12, v12 quad_perm:[1,0,3,2] row_mask:0xf bank_mask:0xf
  s_nop 0
  v_add_f32_dpp v10, v10, v10 quad_perm:[2,3,0,1] row_mask:0xf bank_mask:0xf
  v_add_f32_dpp v12, v12, v12 quad_perm:[2,3,0,1] row_mask:0xf bank_mask:0xf
  s_nop 0
  v_add_f32_dpp v10, v10, v10 row_half_mirror row_mask:0xf bank_mask:0xf
  v_add_f32_dpp v12, v12, v12 row_half_mirror row_mask:0xf bank_mask:0xf
  s_nop 0
  v_add_f32_dpp v10, v10, v10 row_mirror row_mask:0xf bank_mask:0xf
  v_add_f32_dpp v12, v12, v12 row_mirror row_mask:0xf bank_mask:0xf
  s_nop 0
  v_mov_b32 v11, v10
  v_mov_b32 v13, v12
  s_nop 0
  v_permlane16_swap_b32 v11, v10
  v_permlane16_swap_b32 v13, v12
  s_nop 0
  v_add_f32 v10, v11, v10
  v_add_f32 v12, v13, v12
  v_mul_f32 v10, 0x3a800000, v10
  v_mul_f32 v12, 0x3a800000, v12
  v_fma_f32 v12, -v10, v10, v12
  v_add_f32 v12, 0x3727c5ac, v12
  v_rsq_f32 v12, v12
  s_nop 0
  v_mul_f32 v13, v10, v12
  v_sub_f32 v13, 0, v13
  ds_write_b64 v7, v[12:13] offset:0
  s_barrier
  v_mov_b32 v10, 0
  v_mov_b32 v12, 0
  v_mov_b32 v11, 0
  v_mov_b32 v13, 0
  v_dot2_f32_bf16 v10, v32, v8, v10
  v_dot2_f32_bf16 v12, v32, v32, v12
  v_dot2_f32_bf16 v11, v33, v8, v11
  v_dot2_f32_bf16 v13, v33, v33, v13
  v_dot2_f32_bf16 v10, v34, v8, v10
  v_dot2_f32_bf16 v12, v34, v34, v12
  v_dot2_f32_bf16 v11, v35, v8, v11
  v_dot2_f32_bf16 v13, v35, v35, v13
  v_dot2_f32_bf16 v10, v36, v8, v10
  v_dot2_f32_bf16 v12, v36, v36, v12
  v_dot2_f32_bf16 v11, v37, v8, v11
  v_dot2_f32_bf16 v13, v37, v37, v13
  v_dot2_f32_bf16 v10, v38, v8, v10
  v_dot2_f32_bf16 v12, v38, v38, v12
  v_dot2_f32_bf16 v11, v39, v8, v11
  v_dot2_f32_bf16 v13, v39, v39, v13
  v_dot2_f32_bf16 v10, v40, v8, v10
  v_dot2_f32_bf16 v12, v40, v40, v12
  v_dot2_f32_bf16 v11, v41, v8, v11
  v_dot2_f32_bf16 v13, v41, v41, v13
  v_dot2_f32_bf16 v10, v42, v8, v10
  v_dot2_f32_bf16 v12, v42, v42, v12
  v_dot2_f32_bf16 v11, v43, v8, v11
  v_dot2_f32_bf16 v13, v43, v43, v13
  v_dot2_f32_bf16 v10, v44, v8, v10
  v_dot2_f32_bf16 v12, v44, v44, v12
  v_dot2_f32_bf16 v11, v45, v8, v11
  v_dot2_f32_bf16 v13, v45, v45, v13
  v_dot2_f32_bf16 v10, v46, v8, v10
  v_dot2_f32_bf16 v12, v46, v46, v12
  v_dot2_f32_bf16 v11, v47, v8, v11
  v_dot2_f32_bf16 v13, v47, v47, v13
  s_nop 2
  v_add_f32 v10, v10, v11
  v_add_f32 v12, v12, v13
  s_nop 0
  v_add_f32_dpp v10, v10, v10 quad_perm:[1,0,3,2] row_mask:0xf bank_mask:0xf
  v_add_f32_dpp v12, v12, v12 quad_perm:[1,0,3,2] row_mask:0xf bank_mask:0xf
  s_nop 0
  v_add_f32_dpp v10, v10, v10 quad_perm:[2,3,0,1] row_mask:0xf bank_mask:0xf
  v_add_f32_dpp v12, v12, v12 quad_perm:[2,3,0,1] row_mask:0xf bank_mask:0xf
  s_nop 0
  v_add_f32_dpp v10, v10, v10 row_half_mirror row_mask:0xf bank_mask:0xf
  v_add_f32_dpp v12, v12, v12 row_half_mirror row_mask:0xf bank_mask:0xf
  s_nop 0
  v_add_f32_dpp v10, v10, v10 row_mirror row_mask:0xf bank_mask:0xf
  v_add_f32_dpp v12, v12, v12 row_mirror row_mask:0xf bank_mask:0xf
  s_nop 0
  v_mov_b32 v11, v10
  v_mov_b32 v13, v12
  s_nop 0
  v_permlane16_swap_b32 v11, v10
  v_permlane16_swap_b32 v13, v12
  s_nop 0
  v_add_f32 v10, v11, v10
  v_add_f32 v12, v13, v12
  v_mul_f32 v10, 0x3a800000, v10
  v_mul_f32 v12, 0x3a800000, v12
  v_fma_f32 v12, -v10, v10, v12
  v_add_f32 v12, 0x3727c5ac, v12
  v_rsq_f32 v12, v12
  s_nop 0
  v_mul_f32 v13, v10, v12
  v_sub_f32 v13, 0, v13
  ds_write_b64 v7, v[12:13] offset:16
  s_barrier
  v_lshlrev_b32 v50, 16, v64
  v_and_b32 v51, 0xffff0000, v64
  v_lshlrev_b32 v52, 16, v65
  v_and_b32 v53, 0xffff0000, v65
  v_lshlrev_b32 v54, 16, v66
  v_and_b32 v55, 0xffff0000, v66
  v_lshlrev_b32 v56, 16, v67
  v_and_b32 v57, 0xffff0000, v67
  v_lshlrev_b32 v58, 16, v68
  v_and_b32 v59, 0xffff0000, v68
  v_pk_add_f32 v[50:51], v[50:51], v[58:59]
  v_lshlrev_b32 v58, 16, v69
  v_and_b32 v59, 0xffff0000, v69
  v_pk_add_f32 v[52:53], v[52:53], v[58:59]
  v_lshlrev_b32 v58, 16, v70
  v_and_b32 v59, 0xffff0000, v70
  v_pk_add_f32 v[54:55], v[54:55], v[58:59]
  v_lshlrev_b32 v58, 16, v71
  v_and_b32 v59, 0xffff0000, v71
  v_pk_add_f32 v[56:57], v[56:57], v[58:59]
  v_lshlrev_b32 v58, 16, v72
  v_and_b32 v59, 0xffff0000, v72
  v_pk_add_f32 v[50:51], v[50:51], v[58:59]
  v_lshlrev_b32 v58, 16, v73
  v_and_b32 v59, 0xffff0000, v73
  v_pk_add_f32 v[52:53], v[52:53], v[58:59]
  v_lshlrev_b32 v58, 16, v74
  v_and_b32 v59, 0xffff0000, v74
  v_pk_add_f32 v[54:55], v[54:55], v[58:59]
  v_lshlrev_b32 v58, 16, v75
  v_and_b32 v59, 0xffff0000, v75
  v_pk_add_f32 v[56:57], v[56:57], v[58:59]
  v_lshlrev_b32 v58, 16, v76
  v_and_b32 v59, 0xffff0000, v76
  v_pk_add_f32 v[50:51], v[50:51], v[58:59]
  v_lshlrev_b32 v58, 16, v77
  v_and_b32 v59, 0xffff0000, v77
  v_pk_add_f32 v[52:53], v[52:53], v[58:59]
  v_lshlrev_b32 v58, 16, v78
  v_and_b32 v59, 0xffff0000, v78
  v_pk_add_f32 v[54:55], v[54:55], v[58:59]
  v_lshlrev_b32 v58, 16, v79
  v_and_b32 v59, 0xffff0000, v79
  v_pk_add_f32 v[56:57], v[56:57], v[58:59]
  v_lshlrev_b32 v58, 16, v80
  v_and_b32 v59, 0xffff0000, v80
  v_pk_add_f32 v[50:51], v[50:51], v[58:59]
  v_lshlrev_b32 v58, 16, v81
  v_and_b32 v59, 0xffff0000, v81
  v_pk_add_f32 v[52:53], v[52:53], v[58:59]
  v_lshlrev_b32 v58, 16, v82
  v_and_b32 v59, 0xffff0000, v82
  v_pk_add_f32 v[54:55], v[54:55], v[58:59]
  v_lshlrev_b32 v58, 16, v83
  v_and_b32 v59, 0xffff0000, v83
  v_pk_add_f32 v[56:57], v[56:57], v[58:59]
  v_lshlrev_b32 v58, 16, v84
  v_and_b32 v59, 0xffff0000, v84
  v_pk_add_f32 v[50:51], v[50:51], v[58:59]
  v_lshlrev_b32 v58, 16, v85
  v_and_b32 v59, 0xffff0000, v85
  v_pk_add_f32 v[52:53], v[52:53], v[58:59]
  v_lshlrev_b32 v58, 16, v86
  v_and_b32 v59, 0xffff0000, v86
  v_pk_add_f32 v[54:55], v[54:55], v[58:59]
  v_lshlrev_b32 v58, 16, v87
  v_and_b32 v59, 0xffff0000, v87
  v_pk_add_f32 v[56:57], v[56:57], v[58:59]
  s_barrier
  v_lshlrev_b32 v58, 16, v88
  v_and_b32 v59, 0xffff0000, v88
  v_pk_add_f32 v[50:51], v[50:51], v[58:59]
  v_lshlrev_b32 v58, 16, v89
  v_and_b32 v59, 0xffff0000, v89
  v_pk_add_f32 v[52:53], v[52:53], v[58:59]
  v_lshlrev_b32 v58, 16, v90
  v_and_b32 v59, 0xffff0000, v90
  v_pk_add_f32 v[54:55], v[54:55], v[58:59]
  v_lshlrev_b32 v58, 16, v91
  v_and_b32 v59, 0xffff0000, v91
  v_pk_add_f32 v[56:57], v[56:57], v[58:59]
  v_lshlrev_b32 v58, 16, v92
  v_and_b32 v59, 0xffff0000, v92
  v_pk_add_f32 v[50:51], v[50:51], v[58:59]
  v_lshlrev_b32 v58, 16, v93
  v_and_b32 v59, 0xffff0000, v93
  v_pk_add_f32 v[52:53], v[52:53], v[58:59]
  v_lshlrev_b32 v58, 16, v94
  v_and_b32 v59, 0xffff0000, v94
  v_pk_add_f32 v[54:55], v[54:55], v[58:59]
  v_lshlrev_b32 v58, 16, v95
  v_and_b32 v59, 0xffff0000, v95
  v_pk_add_f32 v[56:57], v[56:57], v[58:59]
  v_lshlrev_b32 v58, 16, v96
  v_and_b32 v59, 0xffff0000, v96
  v_pk_add_f32 v[50:51], v[50:51], v[58:59]
  v_lshlrev_b32 v58, 16, v97
  v_and_b32 v59, 0xffff0000, v97
  v_pk_add_f32 v[52:53], v[52:53], v[58:59]
  v_lshlrev_b32 v58, 16, v98
  v_and_b32 v59, 0xffff0000, v98
  v_pk_add_f32 v[54:55], v[54:55], v[58:59]
  v_lshlrev_b32 v58, 16, v99
  v_and_b32 v59, 0xffff0000, v99
  v_pk_add_f32 v[56:57], v[56:57], v[58:59]
  v_lshlrev_b32 v58, 16, v100
  v_and_b32 v59, 0xffff0000, v100
  v_pk_add_f32 v[50:51], v[50:51], v[58:59]
  v_lshlrev_b32 v58, 16, v101
  v_and_b32 v59, 0xffff0000, v101
  v_pk_add_f32 v[52:53], v[52:53], v[58:59]
  v_lshlrev_b32 v58, 16, v102
  v_and_b32 v59, 0xffff0000, v102
  v_pk_add_f32 v[54:55], v[54:55], v[58:59]
  v_lshlrev_b32 v58, 16, v103
  v_and_b32 v59, 0xffff0000, v103
  v_pk_add_f32 v[56:57], v[56:57], v[58:59]
  v_lshlrev_b32 v58, 16, v104
  v_and_b32 v59, 0xffff0000, v104
  v_pk_add_f32 v[50:51], v[50:51], v[58:59]
  v_lshlrev_b32 v58, 16, v105
  v_and_b32 v59, 0xffff0000, v105
  v_pk_add_f32 v[52:53], v[52:53], v[58:59]
  v_lshlrev_b32 v58, 16, v106
  v_and_b32 v59, 0xffff0000, v106
  v_pk_add_f32 v[54:55], v[54:55], v[58:59]
  v_lshlrev_b32 v58, 16, v107
  v_and_b32 v59, 0xffff0000, v107
  v_pk_add_f32 v[56:57], v[56:57], v[58:59]
  s_barrier
  v_lshlrev_b32 v58, 16, v108
  v_and_b32 v59, 0xffff0000, v108
  v_pk_add_f32 v[50:51], v[50:51], v[58:59]
  v_lshlrev_b32 v58, 16, v109
  v_and_b32 v59, 0xffff0000, v109
  v_pk_add_f32 v[52:53], v[52:53], v[58:59]
  v_lshlrev_b32 v58, 16, v110
  v_and_b32 v59, 0xffff0000, v110
  v_pk_add_f32 v[54:55], v[54:55], v[58:59]
  v_lshlrev_b32 v58, 16, v111
  v_and_b32 v59, 0xffff0000, v111
  v_pk_add_f32 v[56:57], v[56:57], v[58:59]
  v_lshlrev_b32 v58, 16, v112
  v_and_b32 v59, 0xffff0000, v112
  v_pk_add_f32 v[50:51], v[50:51], v[58:59]
  v_lshlrev_b32 v58, 16, v113
  v_and_b32 v59, 0xffff0000, v113
  v_pk_add_f32 v[52:53], v[52:53], v[58:59]
  v_lshlrev_b32 v58, 16, v114
  v_and_b32 v59, 0xffff0000, v114
  v_pk_add_f32 v[54:55], v[54:55], v[58:59]
  v_lshlrev_b32 v58, 16, v115
  v_and_b32 v59, 0xffff0000, v115
  v_pk_add_f32 v[56:57], v[56:57], v[58:59]
  v_lshlrev_b32 v58, 16, v116
  v_and_b32 v59, 0xffff0000, v116
  v_pk_add_f32 v[50:51], v[50:51], v[58:59]
  v_lshlrev_b32 v58, 16, v117
  v_and_b32 v59, 0xffff0000, v117
  v_pk_add_f32 v[52:53], v[52:53], v[58:59]
  v_lshlrev_b32 v58, 16, v118
  v_and_b32 v59, 0xffff0000, v118
  v_pk_add_f32 v[54:55], v[54:55], v[58:59]
  v_lshlrev_b32 v58, 16, v119
  v_and_b32 v59, 0xffff0000, v119
  v_pk_add_f32 v[56:57], v[56:57], v[58:59]
  v_lshlrev_b32 v58, 16, v120
  v_and_b32 v59, 0xffff0000, v120
  v_pk_add_f32 v[50:51], v[50:51], v[58:59]
  v_lshlrev_b32 v58, 16, v121
  v_and_b32 v59, 0xffff0000, v121
  v_pk_add_f32 v[52:53], v[52:53], v[58:59]
  v_lshlrev_b32 v58, 16, v122
  v_and_b32 v59, 0xffff0000, v122
  v_pk_add_f32 v[54:55], v[54:55], v[58:59]
  v_lshlrev_b32 v58, 16, v123
  v_and_b32 v59, 0xffff0000, v123
  v_pk_add_f32 v[56:57], v[56:57], v[58:59]
  v_lshlrev_b32 v58, 16, v124
  v_and_b32 v59, 0xffff0000, v124
  v_pk_add_f32 v[50:51], v[50:51], v[58:59]
  v_lshlrev_b32 v58, 16, v125
  v_and_b32 v59, 0xffff0000, v125
  v_pk_add_f32 v[52:53], v[52:53], v[58:59]
  v_lshlrev_b32 v58, 16, v126
  v_and_b32 v59, 0xffff0000, v126
  v_pk_add_f32 v[54:55], v[54:55], v[58:59]
  v_lshlrev_b32 v58, 16, v127
  v_and_b32 v59, 0xffff0000, v127
  v_pk_add_f32 v[56:57], v[56:57], v[58:59]
  ds_write_b128 v9, v[50:53]
  ds_write_b128 v9, v[54:57] offset:16
  s_waitcnt lgkmcnt(0)
  s_barrier
  v_readfirstlane_b32 s33, v49
  s_nop 3
  s_cmp_lg_u32 s33, 0
  s_cbranch_scc1 qa_ng_ok
  v_mov_b32 v2, 0
  s_mov_b32 s43, 0x8000
qa_ng:
  global_load_dword v3, v2, s[54:55] sc1
  s_sub_u32 s43, s43, 1
  s_waitcnt vmcnt(0)
  v_readfirstlane_b32 s33, v3
  s_cmp_eq_u32 s43, 0
  s_cbranch_scc1 qa_ng_x
  s_cmp_eq_u32 s33, 0
  s_cbranch_scc1 qa_ng
qa_ng_x:
qa_ng_ok:
  s_cmp_lg_u32 s3, 6
  s_cbranch_scc1 qa_nopub
  v_min_u32 v2, 47, v0
  v_lshlrev_b32 v3, 4, v2
  v_add_u32 v4, 122880, v3
  ds_read_b128 v[64:67], v4 offset:0
  ds_read_b128 v[68:71], v4 offset:768
  ds_read_b128 v[72:75], v4 offset:1536
  ds_read_b128 v[76:79], v4 offset:2304
  v_min_u32 v5, 7, v0
  v_lshlrev_b32 v5, 3, v5
  v_add_u32 v6, 129024, v5
  ds_read_b64 v[20:21], v6
  s_mul_i32 s43, s37, 12288
  s_mul_i32 s44, s38, 768
  s_add_u32 s43, s43, s44
  v_add_u32 v3, s43, v3
  s_lshl_b32 s43, s2, 6
  v_add_u32 v5, s43, v5
  s_waitcnt lgkmcnt(0)
  v_pk_add_f32 v[64:65], v[64:65], v[68:69]
  v_pk_add_f32 v[66:67], v[66:67], v[70:71]
  v_pk_add_f32 v[64:65], v[64:65], v[72:73]
  v_pk_add_f32 v[66:67], v[66:67], v[74:75]
  v_pk_add_f32 v[64:65], v[64:65], v[76:77]
  v_pk_add_f32 v[66:67], v[66:67], v[78:79]
  s_mov_b64 s[50:51], exec
  s_mov_b32 exec_lo, -1
  s_mov_b32 exec_hi, 0xffff
  buffer_store_dwordx4 v[64:67], v3, s[20:23], 0 offen sc1
  s_mov_b32 exec_lo, 0xff
  s_mov_b32 exec_hi, 0
  buffer_store_dwordx2 v[20:21], v5, s[16:19], 0 offen sc1
  s_mov_b64 exec, s[50:51]
qa_nopub:
  s_barrier
  s_barrier
  s_cmp_lg_u32 s3, 6
  s_cbranch_scc1 qa_nosig
  s_waitcnt vmcnt(0)
  s_lshr_b32 s52, s2, 4
  s_and_b32 s53, s2, 15
  s_mul_i32 s43, s52, 4096
  s_mul_i32 s50, s53, 128
  s_add_u32 s43, s43, s50
  s_add_u32 s43, s43, 262144
  v_mov_b32 v2, s43
  v_mov_b32 v3, s33
  s_mov_b64 s[50:51], exec
  s_mov_b64 exec, 1
  buffer_store_dword v3, v2, s[4:7], 0 offen sc0 sc1
  s_mov_b64 exec, s[50:51]
  s_mul_i32 s43, s38, 4096
  s_mul_i32 s50, s37, 128
  s_add_u32 s43, s43, s50
  s_add_u32 s43, s43, 327680
  v_mov_b32 v2, s43
  v_mov_b32 v3, s33
  s_mov_b64 s[50:51], exec
  s_mov_b64 exec, 1
  buffer_store_dword v3, v2, s[4:7], 0 offen sc0 sc1
  s_mov_b64 exec, s[50:51]
qa_nosig:
  s_barrier
  s_barrier
  s_mul_i32 s48, s37, 4096
  s_add_u32 s48, s48, 262144
  v_and_b32 v60, 15, v0
  v_mul_u32_u24 v60, 128, v60
  v_add_u32 v61, s48, v60
  s_mul_i32 s48, s38, 4096
  s_add_u32 s48, s48, 327680
  v_add_u32 v60, s48, v60
  v_cmp_gt_u32 vcc, 16, v0
  s_nop 1
  v_cndmask_b32 v60, v60, v61, vcc
  buffer_load_dword v62, v60, s[4:7], 0 offen sc1
  s_barrier
  s_waitcnt vmcnt(0)
  v_cmp_ne_u32 vcc, s33, v62
  s_nop 4
  s_cbranch_vccz qa_fl_ok
  s_mov_b32 s48, 0x8000
qa_fl_spin:
  buffer_load_dword v62, v60, s[4:7], 0 offen sc1
  s_sub_u32 s48, s48, 1
  s_cmp_eq_u32 s48, 0
  s_cbranch_scc1 qa_fl_ok
  s_waitcnt vmcnt(0)
  v_cmp_ne_u32 vcc, s33, v62
  s_nop 4
  s_cbranch_vccnz qa_fl_spin
qa_fl_ok:
  s_waitcnt vmcnt(0)
  s_lshl_b32 s48, s46, 6
  v_add_u32 v63, s48, v0
  s_lshl_b32 s48, s37, 10
  v_lshl_add_u32 v65, v63, 3, s48
  buffer_load_dwordx2 v[68:69], v65, s[16:19], 0 offen sc1
  v_min_u32 v66, 95, v63
  v_lshrrev_b32 v67, 1, v66
  v_and_b32 v66, 1, v66
  v_mul_u32_u24 v66, 98304, v66
  v_lshl_add_u32 v66, v67, 4, v66
  s_mul_i32 s48, s38, 768
  v_add_u32 v66, s48, v66
  s_mov_b32 s48, 0
  buffer_load_dwordx4 v[72:75], v66, s[20:23], s48 offen sc1
  s_mov_b32 s48, 12288
  buffer_load_dwordx4 v[76:79], v66, s[20:23], s48 offen sc1
  s_mov_b32 s48, 24576
  buffer_load_dwordx4 v[80:83], v66, s[20:23], s48 offen sc1
  s_mov_b32 s48, 36864
  buffer_load_dwordx4 v[84:87], v66, s[20:23], s48 offen sc1
  s_mov_b32 s48, 49152
  buffer_load_dwordx4 v[88:91], v66, s[20:23], s48 offen sc1
  s_mov_b32 s48, 61440
  buffer_load_dwordx4 v[92:95], v66, s[20:23], s48 offen sc1
  s_mov_b32 s48, 73728
  buffer_load_dwordx4 v[96:99], v66, s[20:23], s48 offen sc1
  s_mov_b32 s48, 86016
  buffer_load_dwordx4 v[100:103], v66, s[20:23], s48 offen sc1
  s_barrier
  s_barrier
  s_waitcnt vmcnt(0)
  v_pk_add_f32 v[72:73], v[72:73], v[76:77]
  v_pk_add_f32 v[74:75], v[74:75], v[78:79]
  v_pk_add_f32 v[72:73], v[72:73], v[80:81]
  v_pk_add_f32 v[74:75], v[74:75], v[82:83]
  v_pk_add_f32 v[72:73], v[72:73], v[84:85]
  v_pk_add_f32 v[74:75], v[74:75], v[86:87]
  v_pk_add_f32 v[72:73], v[72:73], v[88:89]
  v_pk_add_f32 v[74:75], v[74:75], v[90:91]
  v_pk_add_f32 v[72:73], v[72:73], v[92:93]
  v_pk_add_f32 v[74:75], v[74:75], v[94:95]
  v_pk_add_f32 v[72:73], v[72:73], v[96:97]
  v_pk_add_f32 v[74:75], v[74:75], v[98:99]
  v_pk_add_f32 v[72:73], v[72:73], v[100:101]
  v_pk_add_f32 v[74:75], v[74:75], v[102:103]
  s_nop 1
  v_add_f32_dpp v72, v72, v72 quad_perm:[1,0,3,2] row_mask:0xf bank_mask:0xf
  v_add_f32_dpp v73, v73, v73 quad_perm:[1,0,3,2] row_mask:0xf bank_mask:0xf
  v_add_f32_dpp v74, v74, v74 quad_perm:[1,0,3,2] row_mask:0xf bank_mask:0xf
  v_add_f32_dpp v75, v75, v75 quad_perm:[1,0,3,2] row_mask:0xf bank_mask:0xf
  v_lshlrev_b32 v64, 3, v63
  v_add_u32 v64, 129280, v64
  ds_write_b64 v64, v[68:69]
  v_lshlrev_b32 v67, 4, v67
  v_add_u32 v67, 130304, v67
  v_cmp_gt_u32 vcc, 96, v63
  s_and_saveexec_b64 s[48:49], vcc
  s_cbranch_execz qa_ncs
  ds_write_b128 v67, v[72:75]
qa_ncs:
  s_mov_b64 exec, s[48:49]
  s_waitcnt lgkmcnt(0)
  s_barrier
  s_barrier
L_qkv_end:
  s_barrier
  s_cmp_ge_u32 s3, 6
  s_cbranch_scc1 L_ngo
  v_mov_b32 v2, 0
  s_mov_b32 s44, 0x8000
L_ng:
  global_load_dword v3, v2, s[54:55] sc1
  s_sub_u32 s44, s44, 1
  s_waitcnt vmcnt(0)
  v_readfirstlane_b32 s33, v3
  s_cmp_eq_u32 s44, 0
  s_cbranch_scc1 L_ng_x
  s_cmp_eq_u32 s33, 0
  s_cbranch_scc1 L_ng
L_ng_x:
L_ngo:
  s_cmp_lg_u32 s3, 5
  s_cbranch_scc1 npf_a1
  s_getpc_b64 s[52:53]
pc_a1:
  s_sub_u32 s52, s52, pc_a1-C_att
  s_subb_u32 s53, s53, 0
  v_lshlrev_b32 v57, 7, v0
  v_min_u32 v58, C_wo2-C_att-4, v57
  global_load_dword v59, v58, s[52:53]
npf_a1:
  s_cmp_lg_u32 s3, 6
  s_cbranch_scc1 npf_a2
  s_getpc_b64 s[52:53]
pc_a2:
  s_add_u32 s52, s52, att_dep-pc_a2
  s_addc_u32 s53, s53, 0
  v_lshlrev_b32 v57, 7, v0
  v_min_u32 v58, att_slow-att_dep-4, v57
  global_load_dword v59, v58, s[52:53]
npf_a2:
  s_barrier
  s_cmp_lg_u32 s3, 4
  s_cbranch_scc1 L_s1
  s_mul_i32 s43, s38, 4096
  s_mul_i32 s50, s37, 128
  s_add_u32 s43, s43, s50
  s_add_u32 s43, s43, 0
  v_mov_b32 v2, s43
  v_mov_b32 v3, s33
  s_mov_b64 s[50:51], exec
  s_mov_b64 exec, 1
  buffer_store_dword v3, v2, s[4:7], 0 offen sc0 sc1
  s_mov_b64 exec, s[50:51]
L_s1:
  s_branch L_att
att_dep:
  s_barrier
  buffer_load_dwordx4 v[8:11], v1, s[8:11], s48 offen
  buffer_load_dwordx4 v[12:15], v1, s[8:11], s48 offen offset:1024
  buffer_load_dwordx4 v[16:19], v1, s[8:11], s49 offen
  buffer_load_dwordx4 v[20:23], v1, s[8:11], s49 offen offset:1024
  buffer_load_dwordx4 v[232:235], v1, s[8:11], s50 offen
  buffer_load_dwordx4 v[236:239], v1, s[8:11], s50 offen offset:1024
  buffer_load_dwordx4 v[176:179], v1, s[8:11], s41 offen
  buffer_load_dwordx4 v[180:183], v1, s[8:11], s41 offen offset:1024
  s_add_u32 s41, s41, 2048
  buffer_load_dwordx4 v[184:187], v1, s[8:11], s41 offen
  buffer_load_dwordx4 v[188:191], v1, s[8:11], s41 offen offset:1024
  s_add_u32 s41, s41, 2048
  buffer_load_dwordx4 v[208:211], v1, s[8:11], s42 offen
  buffer_load_dwordx4 v[212:215], v1, s[8:11], s42 offen offset:1024
  s_add_u32 s42, s42, 2048
  buffer_load_dwordx4 v[192:195], v1, s[8:11], s41 offen
  buffer_load_dwordx4 v[196:199], v1, s[8:11], s41 offen offset:1024
  s_add_u32 s41, s41, 2048
  buffer_load_dwordx4 v[216:219], v1, s[8:11], s42 offen
  buffer_load_dwordx4 v[220:223], v1, s[8:11], s42 offen offset:1024
  s_add_u32 s42, s42, 2048
  buffer_load_dwordx4 v[200:203], v1, s[8:11], s41 offen
  buffer_load_dwordx4 v[204:207], v1, s[8:11], s41 offen offset:1024
  s_add_u32 s41, s41, 2048
  buffer_load_dwordx4 v[224:227], v1, s[8:11], s42 offen
  buffer_load_dwordx4 v[228:231], v1, s[8:11], s42 offen offset:1024
  s_add_u32 s42, s42, 2048
  s_waitcnt vmcnt(12)
  v_mfma_f32_32x32x16_bf16 v[112:127], v[232:235], v[8:11], 0
  v_mfma_f32_32x32x16_bf16 v[112:127], v[236:239], v[12:15], v[112:127]
  v_mfma_f32_32x32x16_bf16 v[144:159], v[232:235], v[16:19], 0
  v_mfma_f32_32x32x16_bf16 v[144:159], v[236:239], v[20:23], v[144:159]
  s_nop 15
  s_nop 3
  v_max3_f32 v2, v112, v113, v114
  v_max3_f32 v2, v2, v115, v116
  v_max3_f32 v2, v2, v117, v118
  v_max3_f32 v2, v2, v119, v120
  v_max3_f32 v2, v2, v121, v122
  v_max3_f32 v2, v2, v123, v124
  v_max3_f32 v2, v2, v125, v126
  v_max_f32 v2, v2, v127
  v_mov_b32 v3, v2
  s_nop 1
  v_permlane32_swap_b32 v3, v2
  s_nop 1
  v_max_f32 v2, v2, v3
  v_sub_f32 v2, 0, v2
  v_mov_b32 v64, v2
  v_mov_b32 v65, v2
  v_mov_b32 v66, v2
  v_mov_b32 v67, v2
  v_mov_b32 v68, v2
  v_mov_b32 v69, v2
  v_mov_b32 v70, v2
  v_mov_b32 v71, v2
  v_mov_b32 v72, v2
  v_mov_b32 v73, v2
  v_mov_b32 v74, v2
  v_mov_b32 v75, v2
  v_mov_b32 v76, v2
  v_mov_b32 v77, v2
  v_mov_b32 v78, v2
  v_mov_b32 v79, v2
  v_max3_f32 v2, v144, v145, v146
  v_max3_f32 v2, v2, v147, v148
  v_max3_f32 v2, v2, v149, v150
  v_max3_f32 v2, v2, v151, v152
  v_max3_f32 v2, v2, v153, v154
  v_max3_f32 v2, v2, v155, v156
  v_max3_f32 v2, v2, v157, v158
  v_max_f32 v2, v2, v159
  v_mov_b32 v3, v2
  s_nop 1
  v_permlane32_swap_b32 v3, v2
  s_nop 1
  v_max_f32 v2, v2, v3
  v_sub_f32 v2, 0, v2
  v_mov_b32 v80, v2
  v_mov_b32 v81, v2
  v_mov_b32 v82, v2
  v_mov_b32 v83, v2
  v_mov_b32 v84, v2
  v_mov_b32 v85, v2
  v_mov_b32 v86, v2
  v_mov_b32 v87, v2
  v_mov_b32 v88, v2
  v_mov_b32 v89, v2
  v_mov_b32 v90, v2
  v_mov_b32 v91, v2
  v_mov_b32 v92, v2
  v_mov_b32 v93, v2
  v_mov_b32 v94, v2
  v_mov_b32 v95, v2
  v_mov_b32 v236, 0
  v_mov_b32 v237, 0
  v_mov_b32 v238, 0
  v_mov_b32 v239, 0
  s_nop 1
  v_mfma_f32_32x32x16_bf16 v[96:111], v[176:179], v[8:11], v[64:79]
  v_mfma_f32_32x32x16_bf16 v[96:111], v[180:183], v[12:15], v[96:111]
  v_mfma_f32_32x32x16_bf16 v[128:143], v[176:179], v[16:19], v[80:95]
  v_mfma_f32_32x32x16_bf16 v[128:143], v[180:183], v[20:23], v[128:143]
  s_nop 7
  s_cmp_eq_u32 s47, 1
  s_cbranch_scc0 att_np
  s_setprio 1
  att_np:
  s_mov_b32 s40, 8
.p2align 6
att_loop:
  s_add_u32 s43, s3, 0
  s_and_b32 s43, s43, 7
  s_add_u32 s43, s43, 1
  s_cmp_eq_u32 s43, s40
  s_cbranch_scc0 att_pfa
  buffer_load_dword v241, v240, s[16:19], s51 offen
att_pfa:
  s_waitcnt vmcnt(8)
  v_mfma_f32_32x32x16_bf16 v[112:127], v[184:187], v[8:11], v[64:79]
  v_exp_f32 v96, v96
  v_exp_f32 v97, v97
  v_exp_f32 v98, v98
  v_exp_f32 v99, v99
  v_mfma_f32_32x32x16_bf16 v[32:47], v[236:239], v[164:167], v[32:47]
  v_cvt_pk_bf16_f32 v160, v96, v97
  v_cvt_pk_bf16_f32 v161, v98, v99
  v_exp_f32 v100, v100
  v_exp_f32 v101, v101
  v_mfma_f32_16x16x32_bf16 v[24:27], v[4:7], v[164:167], v[24:27]
  v_exp_f32 v102, v102
  v_exp_f32 v103, v103
  v_mfma_f32_32x32x16_bf16 v[112:127], v[188:191], v[12:15], v[112:127]
  v_cvt_pk_bf16_f32 v162, v100, v101
  v_cvt_pk_bf16_f32 v163, v102, v103
  v_exp_f32 v104, v104
  v_exp_f32 v105, v105
  v_mfma_f32_32x32x16_bf16 v[32:47], v[208:211], v[160:163], v[32:47]
  v_exp_f32 v106, v106
  v_exp_f32 v107, v107
  v_exp_f32 v108, v108
  v_mfma_f32_16x16x32_bf16 v[24:27], v[4:7], v[160:163], v[24:27]
  v_exp_f32 v109, v109
  v_exp_f32 v110, v110
  v_exp_f32 v111, v111
  v_cvt_pk_bf16_f32 v164, v104, v105
  v_cvt_pk_bf16_f32 v165, v106, v107
  v_cvt_pk_bf16_f32 v166, v108, v109
  v_cvt_pk_bf16_f32 v167, v110, v111
  v_mfma_f32_32x32x16_bf16 v[144:159], v[184:187], v[16:19], v[80:95]
  v_exp_f32 v128, v128
  v_exp_f32 v129, v129
  v_exp_f32 v130, v130
  v_exp_f32 v131, v131
  v_mfma_f32_32x32x16_bf16 v[48:63], v[236:239], v[172:175], v[48:63]
  buffer_load_dwordx4 v[176:179], v1, s[8:11], s41 offen offset:0
  v_cvt_pk_bf16_f32 v168, v128, v129
  v_cvt_pk_bf16_f32 v169, v130, v131
  v_exp_f32 v132, v132
  v_exp_f32 v133, v133
  v_mfma_f32_16x16x32_bf16 v[28:31], v[4:7], v[172:175], v[28:31]
  buffer_load_dwordx4 v[180:183], v1, s[8:11], s41 offen offset:1024
  s_add_u32 s41, s41, 2048
  v_exp_f32 v134, v134
  v_exp_f32 v135, v135
  v_mfma_f32_32x32x16_bf16 v[144:159], v[188:191], v[20:23], v[144:159]
  buffer_load_dwordx4 v[232:235], v1, s[8:11], s42 offen offset:0
  v_cvt_pk_bf16_f32 v170, v132, v133
  v_cvt_pk_bf16_f32 v171, v134, v135
  v_exp_f32 v136, v136
  v_exp_f32 v137, v137
  v_mfma_f32_32x32x16_bf16 v[48:63], v[208:211], v[168:171], v[48:63]
  buffer_load_dwordx4 v[236:239], v1, s[8:11], s42 offen offset:1024
  s_add_u32 s42, s42, 2048
  v_exp_f32 v138, v138
  v_exp_f32 v139, v139
  v_exp_f32 v140, v140
  v_mfma_f32_16x16x32_bf16 v[28:31], v[4:7], v[168:171], v[28:31]
  v_exp_f32 v141, v141
  v_exp_f32 v142, v142
  v_exp_f32 v143, v143
  v_cvt_pk_bf16_f32 v172, v136, v137
  v_cvt_pk_bf16_f32 v173, v138, v139
  v_cvt_pk_bf16_f32 v174, v140, v141
  v_cvt_pk_bf16_f32 v175, v142, v143
  s_waitcnt vmcnt(8)
  v_mfma_f32_32x32x16_bf16 v[96:111], v[192:195], v[8:11], v[64:79]
  v_exp_f32 v112, v112
  v_exp_f32 v113, v113
  v_exp_f32 v114, v114
  v_exp_f32 v115, v115
  v_mfma_f32_32x32x16_bf16 v[32:47], v[212:215], v[164:167], v[32:47]
  v_cvt_pk_bf16_f32 v160, v112, v113
  v_cvt_pk_bf16_f32 v161, v114, v115
  v_exp_f32 v116, v116
  v_exp_f32 v117, v117
  v_mfma_f32_16x16x32_bf16 v[24:27], v[4:7], v[164:167], v[24:27]
  v_exp_f32 v118, v118
  v_exp_f32 v119, v119
  v_mfma_f32_32x32x16_bf16 v[96:111], v[196:199], v[12:15], v[96:111]
  v_cvt_pk_bf16_f32 v162, v116, v117
  v_cvt_pk_bf16_f32 v163, v118, v119
  v_exp_f32 v120, v120
  v_exp_f32 v121, v121
  v_mfma_f32_32x32x16_bf16 v[32:47], v[216:219], v[160:163], v[32:47]
  v_exp_f32 v122, v122
  v_exp_f32 v123, v123
  v_exp_f32 v124, v124
  v_mfma_f32_16x16x32_bf16 v[24:27], v[4:7], v[160:163], v[24:27]
  v_exp_f32 v125, v125
  v_exp_f32 v126, v126
  v_exp_f32 v127, v127
  v_cvt_pk_bf16_f32 v164, v120, v121
  v_cvt_pk_bf16_f32 v165, v122, v123
  v_cvt_pk_bf16_f32 v166, v124, v125
  v_cvt_pk_bf16_f32 v167, v126, v127
  v_mfma_f32_32x32x16_bf16 v[128:143], v[192:195], v[16:19], v[80:95]
  v_exp_f32 v144, v144
  v_exp_f32 v145, v145
  v_exp_f32 v146, v146
  v_exp_f32 v147, v147
  v_mfma_f32_32x32x16_bf16 v[48:63], v[212:215], v[172:175], v[48:63]
  buffer_load_dwordx4 v[184:187], v1, s[8:11], s41 offen offset:0
  v_cvt_pk_bf16_f32 v168, v144, v145
  v_cvt_pk_bf16_f32 v169, v146, v147
  v_exp_f32 v148, v148
  v_exp_f32 v149, v149
  v_mfma_f32_16x16x32_bf16 v[28:31], v[4:7], v[172:175], v[28:31]
  buffer_load_dwordx4 v[188:191], v1, s[8:11], s41 offen offset:1024
  s_add_u32 s41, s41, 2048
  v_exp_f32 v150, v150
  v_exp_f32 v151, v151
  v_mfma_f32_32x32x16_bf16 v[128:143], v[196:199], v[20:23], v[128:143]
  buffer_load_dwordx4 v[208:211], v1, s[8:11], s42 offen offset:0
  v_cvt_pk_bf16_f32 v170, v148, v149
  v_cvt_pk_bf16_f32 v171, v150, v151
  v_exp_f32 v152, v152
  v_exp_f32 v153, v153
  v_mfma_f32_32x32x16_bf16 v[48:63], v[216:219], v[168:171], v[48:63]
  buffer_load_dwordx4 v[212:215], v1, s[8:11], s42 offen offset:1024
  s_add_u32 s42, s42, 2048
  v_exp_f32 v154, v154
  v_exp_f32 v155, v155
  v_exp_f32 v156, v156
  v_mfma_f32_16x16x32_bf16 v[28:31], v[4:7], v[168:171], v[28:31]
  v_exp_f32 v157, v157
  v_exp_f32 v158, v158
  v_exp_f32 v159, v159
  v_cvt_pk_bf16_f32 v172, v152, v153
  v_cvt_pk_bf16_f32 v173, v154, v155
  v_cvt_pk_bf16_f32 v174, v156, v157
  v_cvt_pk_bf16_f32 v175, v158, v159
  s_waitcnt vmcnt(8)
  v_mfma_f32_32x32x16_bf16 v[112:127], v[200:203], v[8:11], v[64:79]
  v_exp_f32 v96, v96
  v_exp_f32 v97, v97
  v_exp_f32 v98, v98
  v_exp_f32 v99, v99
  v_mfma_f32_32x32x16_bf16 v[32:47], v[220:223], v[164:167], v[32:47]
  v_cvt_pk_bf16_f32 v160, v96, v97
  v_cvt_pk_bf16_f32 v161, v98, v99
  v_exp_f32 v100, v100
  v_exp_f32 v101, v101
  v_mfma_f32_16x16x32_bf16 v[24:27], v[4:7], v[164:167], v[24:27]
  v_exp_f32 v102, v102
  v_exp_f32 v103, v103
  v_mfma_f32_32x32x16_bf16 v[112:127], v[204:207], v[12:15], v[112:127]
  v_cvt_pk_bf16_f32 v162, v100, v101
  v_cvt_pk_bf16_f32 v163, v102, v103
  v_exp_f32 v104, v104
  v_exp_f32 v105, v105
  v_mfma_f32_32x32x16_bf16 v[32:47], v[224:227], v[160:163], v[32:47]
  v_exp_f32 v106, v106
  v_exp_f32 v107, v107
  v_exp_f32 v108, v108
  v_mfma_f32_16x16x32_bf16 v[24:27], v[4:7], v[160:163], v[24:27]
  v_exp_f32 v109, v109
  v_exp_f32 v110, v110
  v_exp_f32 v111, v111
  v_cvt_pk_bf16_f32 v164, v104, v105
  v_cvt_pk_bf16_f32 v165, v106, v107
  v_cvt_pk_bf16_f32 v166, v108, v109
  v_cvt_pk_bf16_f32 v167, v110, v111
  v_mfma_f32_32x32x16_bf16 v[144:159], v[200:203], v[16:19], v[80:95]
  v_exp_f32 v128, v128
  v_exp_f32 v129, v129
  v_exp_f32 v130, v130
  v_exp_f32 v131, v131
  v_mfma_f32_32x32x16_bf16 v[48:63], v[220:223], v[172:175], v[48:63]
  buffer_load_dwordx4 v[192:195], v1, s[8:11], s41 offen offset:0
  v_cvt_pk_bf16_f32 v168, v128, v129
  v_cvt_pk_bf16_f32 v169, v130, v131
  v_exp_f32 v132, v132
  v_exp_f32 v133, v133
  v_mfma_f32_16x16x32_bf16 v[28:31], v[4:7], v[172:175], v[28:31]
  buffer_load_dwordx4 v[196:199], v1, s[8:11], s41 offen offset:1024
  s_add_u32 s41, s41, 2048
  v_exp_f32 v134, v134
  v_exp_f32 v135, v135
  v_mfma_f32_32x32x16_bf16 v[144:159], v[204:207], v[20:23], v[144:159]
  buffer_load_dwordx4 v[216:219], v1, s[8:11], s42 offen offset:0
  v_cvt_pk_bf16_f32 v170, v132, v133
  v_cvt_pk_bf16_f32 v171, v134, v135
  v_exp_f32 v136, v136
  v_exp_f32 v137, v137
  v_mfma_f32_32x32x16_bf16 v[48:63], v[224:227], v[168:171], v[48:63]
  buffer_load_dwordx4 v[220:223], v1, s[8:11], s42 offen offset:1024
  s_add_u32 s42, s42, 2048
  v_exp_f32 v138, v138
  v_exp_f32 v139, v139
  v_exp_f32 v140, v140
  v_mfma_f32_16x16x32_bf16 v[28:31], v[4:7], v[168:171], v[28:31]
  v_exp_f32 v141, v141
  v_exp_f32 v142, v142
  v_exp_f32 v143, v143
  v_cvt_pk_bf16_f32 v172, v136, v137
  v_cvt_pk_bf16_f32 v173, v138, v139
  v_cvt_pk_bf16_f32 v174, v140, v141
  v_cvt_pk_bf16_f32 v175, v142, v143
  s_waitcnt vmcnt(8)
  v_mfma_f32_32x32x16_bf16 v[96:111], v[176:179], v[8:11], v[64:79]
  v_exp_f32 v112, v112
  v_exp_f32 v113, v113
  v_exp_f32 v114, v114
  v_exp_f32 v115, v115
  v_mfma_f32_32x32x16_bf16 v[32:47], v[228:231], v[164:167], v[32:47]
  v_cvt_pk_bf16_f32 v160, v112, v113
  v_cvt_pk_bf16_f32 v161, v114, v115
  v_exp_f32 v116, v116
  v_exp_f32 v117, v117
  v_mfma_f32_16x16x32_bf16 v[24:27], v[4:7], v[164:167], v[24:27]
  v_exp_f32 v118, v118
  v_exp_f32 v119, v119
  v_mfma_f32_32x32x16_bf16 v[96:111], v[180:183], v[12:15], v[96:111]
  v_cvt_pk_bf16_f32 v162, v116, v117
  v_cvt_pk_bf16_f32 v163, v118, v119
  v_exp_f32 v120, v120
  v_exp_f32 v121, v121
  v_mfma_f32_32x32x16_bf16 v[32:47], v[232:235], v[160:163], v[32:47]
  v_exp_f32 v122, v122
  v_exp_f32 v123, v123
  v_exp_f32 v124, v124
  v_mfma_f32_16x16x32_bf16 v[24:27], v[4:7], v[160:163], v[24:27]
  v_exp_f32 v125, v125
  v_exp_f32 v126, v126
  v_exp_f32 v127, v127
  v_cvt_pk_bf16_f32 v164, v120, v121
  v_cvt_pk_bf16_f32 v165, v122, v123
  v_cvt_pk_bf16_f32 v166, v124, v125
  v_cvt_pk_bf16_f32 v167, v126, v127
  v_mfma_f32_32x32x16_bf16 v[128:143], v[176:179], v[16:19], v[80:95]
  v_exp_f32 v144, v144
  v_exp_f32 v145, v145
  v_exp_f32 v146, v146
  v_exp_f32 v147, v147
  v_mfma_f32_32x32x16_bf16 v[48:63], v[228:231], v[172:175], v[48:63]
  buffer_load_dwordx4 v[200:203], v1, s[8:11], s41 offen offset:0
  v_cvt_pk_bf16_f32 v168, v144, v145
  v_cvt_pk_bf16_f32 v169, v146, v147
  v_exp_f32 v148, v148
  v_exp_f32 v149, v149
  v_mfma_f32_16x16x32_bf16 v[28:31], v[4:7], v[172:175], v[28:31]
  buffer_load_dwordx4 v[204:207], v1, s[8:11], s41 offen offset:1024
  s_add_u32 s41, s41, 2048
  v_exp_f32 v150, v150
  v_exp_f32 v151, v151
  v_mfma_f32_32x32x16_bf16 v[128:143], v[180:183], v[20:23], v[128:143]
  buffer_load_dwordx4 v[224:227], v1, s[8:11], s42 offen offset:0
  v_cvt_pk_bf16_f32 v170, v148, v149
  v_cvt_pk_bf16_f32 v171, v150, v151
  v_exp_f32 v152, v152
  v_exp_f32 v153, v153
  v_mfma_f32_32x32x16_bf16 v[48:63], v[232:235], v[168:171], v[48:63]
  buffer_load_dwordx4 v[228:231], v1, s[8:11], s42 offen offset:1024
  s_add_u32 s42, s42, 2048
  v_exp_f32 v154, v154
  v_exp_f32 v155, v155
  v_exp_f32 v156, v156
  v_mfma_f32_16x16x32_bf16 v[28:31], v[4:7], v[168:171], v[28:31]
  v_exp_f32 v157, v157
  v_exp_f32 v158, v158
  v_exp_f32 v159, v159
  v_cvt_pk_bf16_f32 v172, v152, v153
  v_cvt_pk_bf16_f32 v173, v154, v155
  v_cvt_pk_bf16_f32 v174, v156, v157
  v_cvt_pk_bf16_f32 v175, v158, v159
  s_sub_u32 s40, s40, 1
  s_cmp_lg_u32 s40, 0
  s_cbranch_scc1 att_loop
  s_nop 1
  v_mfma_f32_32x32x16_bf16 v[32:47], v[236:239], v[164:167], v[32:47]
  v_mfma_f32_16x16x32_bf16 v[24:27], v[4:7], v[164:167], v[24:27]
  v_mfma_f32_32x32x16_bf16 v[48:63], v[236:239], v[172:175], v[48:63]
  v_mfma_f32_16x16x32_bf16 v[28:31], v[4:7], v[172:175], v[28:31]
  s_setprio 0
  s_nop 15
  s_nop 3
  s_mul_i32 s43, s46, 9216
  s_add_u32 s43, s43, 126976
  v_lshl_add_u32 v2, v0, 4, s43
  s_cmp_eq_u32 s47, 0
  s_cbranch_scc1 att_rd
  ds_write_b128 v2, v[32:35] offset:0
  ds_write_b128 v2, v[36:39] offset:1024
  ds_write_b128 v2, v[40:43] offset:2048
  ds_write_b128 v2, v[44:47] offset:3072
  ds_write_b128 v2, v[48:51] offset:4096
  ds_write_b128 v2, v[52:55] offset:5120
  ds_write_b128 v2, v[56:59] offset:6144
  ds_write_b128 v2, v[60:63] offset:7168
  v_mov_b32 v25, v28
  ds_write_b64 v2, v[24:25] offset:8192
  s_waitcnt vmcnt(0) lgkmcnt(0)
  s_barrier
  s_branch L_wo
att_rd:
  s_waitcnt vmcnt(0)
  s_barrier
  ds_read_b128 v[96:99], v2 offset:0
  ds_read_b128 v[100:103], v2 offset:1024
  ds_read_b128 v[104:107], v2 offset:2048
  ds_read_b128 v[108:111], v2 offset:3072
  ds_read_b128 v[128:131], v2 offset:4096
  ds_read_b128 v[132:135], v2 offset:5120
  ds_read_b128 v[136:139], v2 offset:6144
  ds_read_b128 v[140:143], v2 offset:7168
  ds_read_b64 v[176:177], v2 offset:8192
  s_waitcnt lgkmcnt(0)
  v_pk_add_f32 v[32:33], v[32:33], v[96:97]
  v_pk_add_f32 v[34:35], v[34:35], v[98:99]
  v_pk_add_f32 v[36:37], v[36:37], v[100:101]
  v_pk_add_f32 v[38:39], v[38:39], v[102:103]
  v_pk_add_f32 v[40:41], v[40:41], v[104:105]
  v_pk_add_f32 v[42:43], v[42:43], v[106:107]
  v_pk_add_f32 v[44:45], v[44:45], v[108:109]
  v_pk_add_f32 v[46:47], v[46:47], v[110:111]
  v_add_f32 v24, v24, v176
  v_pk_add_f32 v[48:49], v[48:49], v[128:129]
  v_pk_add_f32 v[50:51], v[50:51], v[130:131]
  v_pk_add_f32 v[52:53], v[52:53], v[132:133]
  v_pk_add_f32 v[54:55], v[54:55], v[134:135]
  v_pk_add_f32 v[56:57], v[56:57], v[136:137]
  v_pk_add_f32 v[58:59], v[58:59], v[138:139]
  v_pk_add_f32 v[60:61], v[60:61], v[140:141]
  v_pk_add_f32 v[62:63], v[62:63], v[142:143]
  v_add_f32 v28, v28, v177
  v_mov_b32 v2, 0x5f800000
  v_cmp_nlt_f32 vcc, v24, v2
  v_cmp_nlt_f32 s[52:53], v28, v2
  s_nop 4
  s_or_b64 vcc, vcc, s[52:53]
  s_cbranch_vccnz att_slow
att_fin:
  s_lshl_b32 s43, s38, 4
  s_lshl_b32 s44, s46, 2
  s_add_u32 s43, s43, s44
  s_lshl_b32 s43, s43, 5
  s_add_u32 s43, s43, s37
  s_lshl_b32 s43, s43, 10
  v_bfe_u32 v3, v0, 4, 1
  v_lshlrev_b32 v3, 15, v3
  v_lshrrev_b32 v2, 5, v0
  v_lshl_add_u32 v3, v2, 8, v3
  v_and_b32 v2, 15, v0
  v_lshl_add_u32 v3, v2, 4, v3
  v_add_u32 v3, s43, v3
  v_rcp_f32 v4, v24
  s_nop 0
  v_mov_b32 v5, v4
  v_pk_mul_f32 v[32:33], v[32:33], v[4:5]
  v_pk_mul_f32 v[34:35], v[34:35], v[4:5]
  v_pk_mul_f32 v[36:37], v[36:37], v[4:5]
  v_pk_mul_f32 v[38:39], v[38:39], v[4:5]
  v_pk_mul_f32 v[40:41], v[40:41], v[4:5]
  v_pk_mul_f32 v[42:43], v[42:43], v[4:5]
  v_pk_mul_f32 v[44:45], v[44:45], v[4:5]
  v_pk_mul_f32 v[46:47], v[46:47], v[4:5]
  v_cvt_pk_bf16_f32 v160, v32, v33
  v_cvt_pk_bf16_f32 v161, v34, v35
  v_cvt_pk_bf16_f32 v162, v36, v37
  v_cvt_pk_bf16_f32 v163, v38, v39
  v_cvt_pk_bf16_f32 v164, v40, v41
  v_cvt_pk_bf16_f32 v165, v42, v43
  v_cvt_pk_bf16_f32 v166, v44, v45
  v_cvt_pk_bf16_f32 v167, v46, v47
  s_mov_b32 s44, 0
  buffer_store_dwordx4 v[160:163], v3, s[12:15], s44 offen sc1
  buffer_store_dwordx4 v[164:167], v3, s[12:15], s44 offen offset:512 sc1
  v_rcp_f32 v4, v28
  s_nop 0
  v_mov_b32 v5, v4
  v_pk_mul_f32 v[48:49], v[48:49], v[4:5]
  v_pk_mul_f32 v[50:51], v[50:51], v[4:5]
  v_pk_mul_f32 v[52:53], v[52:53], v[4:5]
  v_pk_mul_f32 v[54:55], v[54:55], v[4:5]
  v_pk_mul_f32 v[56:57], v[56:57], v[4:5]
  v_pk_mul_f32 v[58:59], v[58:59], v[4:5]
  v_pk_mul_f32 v[60:61], v[60:61], v[4:5]
  v_pk_mul_f32 v[62:63], v[62:63], v[4:5]
  v_cvt_pk_bf16_f32 v168, v48, v49
  v_cvt_pk_bf16_f32 v169, v50, v51
  v_cvt_pk_bf16_f32 v170, v52, v53
  v_cvt_pk_bf16_f32 v171, v54, v55
  v_cvt_pk_bf16_f32 v172, v56, v57
  v_cvt_pk_bf16_f32 v173, v58, v59
  v_cvt_pk_bf16_f32 v174, v60, v61
  v_cvt_pk_bf16_f32 v175, v62, v63
  s_mov_b32 s44, 65536
  buffer_store_dwordx4 v[168:171], v3, s[12:15], s44 offen sc1
  buffer_store_dwordx4 v[172:175], v3, s[12:15], s44 offen offset:512 sc1
  s_branch C_wo
att_slow:
  s_waitcnt vmcnt(0)
  s_mov_b32 s41, s50
  s_add_u32 s42, s50, 4194304
  v_mov_b32 v64, 0xff800000
  v_mov_b32 v24, 0
  v_mov_b32 v25, 0
  v_mov_b32 v26, 0
  v_mov_b32 v27, 0
  v_mov_b32 v32, 0
  v_mov_b32 v33, 0
  v_mov_b32 v34, 0
  v_mov_b32 v35, 0
  v_mov_b32 v36, 0
  v_mov_b32 v37, 0
  v_mov_b32 v38, 0
  v_mov_b32 v39, 0
  v_mov_b32 v40, 0
  v_mov_b32 v41, 0
  v_mov_b32 v42, 0
  v_mov_b32 v43, 0
  v_mov_b32 v44, 0
  v_mov_b32 v45, 0
  v_mov_b32 v46, 0
  v_mov_b32 v47, 0
  v_mov_b32 v80, 0xff800000
  v_mov_b32 v28, 0
  v_mov_b32 v29, 0
  v_mov_b32 v30, 0
  v_mov_b32 v31, 0
  v_mov_b32 v48, 0
  v_mov_b32 v49, 0
  v_mov_b32 v50, 0
  v_mov_b32 v51, 0
  v_mov_b32 v52, 0
  v_mov_b32 v53, 0
  v_mov_b32 v54, 0
  v_mov_b32 v55, 0
  v_mov_b32 v56, 0
  v_mov_b32 v57, 0
  v_mov_b32 v58, 0
  v_mov_b32 v59, 0
  v_mov_b32 v60, 0
  v_mov_b32 v61, 0
  v_mov_b32 v62, 0
  v_mov_b32 v63, 0
  s_mov_b32 s40, 64
att_sloop:
  buffer_load_dwordx4 v[176:179], v1, s[8:11], s41 offen
  buffer_load_dwordx4 v[180:183], v1, s[8:11], s41 offen offset:1024
  s_add_u32 s41, s41, 2048
  buffer_load_dwordx4 v[208:211], v1, s[8:11], s42 offen
  buffer_load_dwordx4 v[212:215], v1, s[8:11], s42 offen offset:1024
  s_add_u32 s42, s42, 2048
  s_waitcnt vmcnt(0)
  v_mfma_f32_32x32x16_bf16 v[96:111], v[176:179], v[8:11], 0
  v_mfma_f32_32x32x16_bf16 v[96:111], v[180:183], v[12:15], v[96:111]
  s_nop 15
  s_nop 3
  v_max3_f32 v2, v96, v97, v98
  v_max3_f32 v2, v2, v99, v100
  v_max3_f32 v2, v2, v101, v102
  v_max3_f32 v2, v2, v103, v104
  v_max3_f32 v2, v2, v105, v106
  v_max3_f32 v2, v2, v107, v108
  v_max3_f32 v2, v2, v109, v110
  v_max_f32 v2, v2, v111
  v_mov_b32 v3, v2
  s_nop 1
  v_permlane32_swap_b32 v3, v2
  s_nop 1
  v_max_f32 v2, v2, v3
  v_max_f32 v2, v2, v64
  v_sub_f32 v3, v64, v2
  v_exp_f32 v3, v3
  v_mov_b32 v64, v2
  s_nop 0
  v_mul_f32 v24, v24, v3
  v_mul_f32 v32, v32, v3
  v_mul_f32 v33, v33, v3
  v_mul_f32 v34, v34, v3
  v_mul_f32 v35, v35, v3
  v_mul_f32 v36, v36, v3
  v_mul_f32 v37, v37, v3
  v_mul_f32 v38, v38, v3
  v_mul_f32 v39, v39, v3
  v_mul_f32 v40, v40, v3
  v_mul_f32 v41, v41, v3
  v_mul_f32 v42, v42, v3
  v_mul_f32 v43, v43, v3
  v_mul_f32 v44, v44, v3
  v_mul_f32 v45, v45, v3
  v_mul_f32 v46, v46, v3
  v_mul_f32 v47, v47, v3
  v_sub_f32 v96, v96, v2
  v_sub_f32 v97, v97, v2
  v_sub_f32 v98, v98, v2
  v_sub_f32 v99, v99, v2
  v_sub_f32 v100, v100, v2
  v_sub_f32 v101, v101, v2
  v_sub_f32 v102, v102, v2
  v_sub_f32 v103, v103, v2
  v_sub_f32 v104, v104, v2
  v_sub_f32 v105, v105, v2
  v_sub_f32 v106, v106, v2
  v_sub_f32 v107, v107, v2
  v_sub_f32 v108, v108, v2
  v_sub_f32 v109, v109, v2
  v_sub_f32 v110, v110, v2
  v_sub_f32 v111, v111, v2
  v_exp_f32 v96, v96
  v_exp_f32 v97, v97
  v_exp_f32 v98, v98
  v_exp_f32 v99, v99
  v_exp_f32 v100, v100
  v_exp_f32 v101, v101
  v_exp_f32 v102, v102
  v_exp_f32 v103, v103
  v_exp_f32 v104, v104
  v_exp_f32 v105, v105
  v_exp_f32 v106, v106
  v_exp_f32 v107, v107
  v_exp_f32 v108, v108
  v_exp_f32 v109, v109
  v_exp_f32 v110, v110
  v_exp_f32 v111, v111
  s_nop 0
  v_cvt_pk_bf16_f32 v160, v96, v97
  v_cvt_pk_bf16_f32 v161, v98, v99
  v_cvt_pk_bf16_f32 v162, v100, v101
  v_cvt_pk_bf16_f32 v163, v102, v103
  v_cvt_pk_bf16_f32 v164, v104, v105
  v_cvt_pk_bf16_f32 v165, v106, v107
  v_cvt_pk_bf16_f32 v166, v108, v109
  v_cvt_pk_bf16_f32 v167, v110, v111
  s_nop 1
  v_mfma_f32_32x32x16_bf16 v[32:47], v[208:211], v[160:163], v[32:47]
  v_mfma_f32_16x16x32_bf16 v[24:27], v[4:7], v[160:163], v[24:27]
  v_mfma_f32_32x32x16_bf16 v[32:47], v[212:215], v[164:167], v[32:47]
  v_mfma_f32_16x16x32_bf16 v[24:27], v[4:7], v[164:167], v[24:27]
  s_nop 15
  s_nop 3
  v_mfma_f32_32x32x16_bf16 v[128:143], v[176:179], v[16:19], 0
  v_mfma_f32_32x32x16_bf16 v[128:143], v[180:183], v[20:23], v[128:143]
  s_nop 15
  s_nop 3
  v_max3_f32 v2, v128, v129, v130
  v_max3_f32 v2, v2, v131, v132
  v_max3_f32 v2, v2, v133, v134
  v_max3_f32 v2, v2, v135, v136
  v_max3_f32 v2, v2, v137, v138
  v_max3_f32 v2, v2, v139, v140
  v_max3_f32 v2, v2, v141, v142
  v_max_f32 v2, v2, v143
  v_mov_b32 v3, v2
  s_nop 1
  v_permlane32_swap_b32 v3, v2
  s_nop 1
  v_max_f32 v2, v2, v3
  v_max_f32 v2, v2, v80
  v_sub_f32 v3, v80, v2
  v_exp_f32 v3, v3
  v_mov_b32 v80, v2
  s_nop 0
  v_mul_f32 v28, v28, v3
  v_mul_f32 v48, v48, v3
  v_mul_f32 v49, v49, v3
  v_mul_f32 v50, v50, v3
  v_mul_f32 v51, v51, v3
  v_mul_f32 v52, v52, v3
  v_mul_f32 v53, v53, v3
  v_mul_f32 v54, v54, v3
  v_mul_f32 v55, v55, v3
  v_mul_f32 v56, v56, v3
  v_mul_f32 v57, v57, v3
  v_mul_f32 v58, v58, v3
  v_mul_f32 v59, v59, v3
  v_mul_f32 v60, v60, v3
  v_mul_f32 v61, v61, v3
  v_mul_f32 v62, v62, v3
  v_mul_f32 v63, v63, v3
  v_sub_f32 v128, v128, v2
  v_sub_f32 v129, v129, v2
  v_sub_f32 v130, v130, v2
  v_sub_f32 v131, v131, v2
  v_sub_f32 v132, v132, v2
  v_sub_f32 v133, v133, v2
  v_sub_f32 v134, v134, v2
  v_sub_f32 v135, v135, v2
  v_sub_f32 v136, v136, v2
  v_sub_f32 v137, v137, v2
  v_sub_f32 v138, v138, v2
  v_sub_f32 v139, v139, v2
  v_sub_f32 v140, v140, v2
  v_sub_f32 v141, v141, v2
  v_sub_f32 v142, v142, v2
  v_sub_f32 v143, v143, v2
  v_exp_f32 v128, v128
  v_exp_f32 v129, v129
  v_exp_f32 v130, v130
  v_exp_f32 v131, v131
  v_exp_f32 v132, v132
  v_exp_f32 v133, v133
  v_exp_f32 v134, v134
  v_exp_f32 v135, v135
  v_exp_f32 v136, v136
  v_exp_f32 v137, v137
  v_exp_f32 v138, v138
  v_exp_f32 v139, v139
  v_exp_f32 v140, v140
  v_exp_f32 v141, v141
  v_exp_f32 v142, v142
  v_exp_f32 v143, v143
  s_nop 0
  v_cvt_pk_bf16_f32 v168, v128, v129
  v_cvt_pk_bf16_f32 v169, v130, v131
  v_cvt_pk_bf16_f32 v170, v132, v133
  v_cvt_pk_bf16_f32 v171, v134, v135
  v_cvt_pk_bf16_f32 v172, v136, v137
  v_cvt_pk_bf16_f32 v173, v138, v139
  v_cvt_pk_bf16_f32 v174, v140, v141
  v_cvt_pk_bf16_f32 v175, v142, v143
  s_nop 1
  v_mfma_f32_32x32x16_bf16 v[48:63], v[208:211], v[168:171], v[48:63]
  v_mfma_f32_16x16x32_bf16 v[28:31], v[4:7], v[168:171], v[28:31]
  v_mfma_f32_32x32x16_bf16 v[48:63], v[212:215], v[172:175], v[48:63]
  v_mfma_f32_16x16x32_bf16 v[28:31], v[4:7], v[172:175], v[28:31]
  s_nop 15
  s_nop 3
  s_sub_u32 s40, s40, 1
  s_cmp_lg_u32 s40, 0
  s_cbranch_scc1 att_sloop
  s_branch att_fin
L_att:
  s_load_dwordx2 s[8:9], s[0:1], 80
  s_load_dwordx2 s[12:13], s[0:1], 80
  s_and_b32 s43, s2, 7
  s_lshr_b32 s44, s2, 3
  s_lshl_b32 s37, s43, 2
  s_lshr_b32 s45, s44, 3
  s_add_u32 s37, s37, s45
  s_and_b32 s38, s44, 7
  s_and_b32 s46, s3, 3
  s_lshr_b32 s47, s3, 2
  s_lshl_b32 s43, s37, 17
  s_add_u32 s50, s43, 4194304
  s_lshl_b32 s44, s47, 16
  s_add_u32 s41, s50, s44
  s_add_u32 s42, s41, 4194304
  v_lshlrev_b32 v1, 4, v0
  s_lshl_b32 s43, s37, 6
  s_lshl_b32 s44, s38, 3
  s_add_u32 s43, s43, s44
  s_lshl_b32 s44, s46, 1
  s_add_u32 s43, s43, s44
  s_lshl_b32 s48, s43, 11
  s_add_u32 s49, s48, 2048
  v_and_b32 v2, 3, v0
  v_bfe_u32 v3, v0, 2, 1
  v_bfe_u32 v4, v0, 4, 1
  v_xor_b32 v3, v3, v4
  v_or_b32 v2, v2, v3
  v_cmp_eq_u32 vcc, 0, v2
  v_mov_b32 v3, 0x3f803f80
  s_nop 0
  v_cndmask_b32 v4, 0, v3, vcc
  v_mov_b32 v5, v4
  v_mov_b32 v6, v4
  v_mov_b32 v7, v4
  v_mov_b32 v24, 0
  v_mov_b32 v25, 0
  v_mov_b32 v26, 0
  v_mov_b32 v27, 0
  v_mov_b32 v32, 0
  v_mov_b32 v33, 0
  v_mov_b32 v34, 0
  v_mov_b32 v35, 0
  v_mov_b32 v36, 0
  v_mov_b32 v37, 0
  v_mov_b32 v38, 0
  v_mov_b32 v39, 0
  v_mov_b32 v40, 0
  v_mov_b32 v41, 0
  v_mov_b32 v42, 0
  v_mov_b32 v43, 0
  v_mov_b32 v44, 0
  v_mov_b32 v45, 0
  v_mov_b32 v46, 0
  v_mov_b32 v47, 0
  v_mov_b32 v164, 0
  v_mov_b32 v165, 0
  v_mov_b32 v166, 0
  v_mov_b32 v167, 0
  v_mov_b32 v28, 0
  v_mov_b32 v29, 0
  v_mov_b32 v30, 0
  v_mov_b32 v31, 0
  v_mov_b32 v48, 0
  v_mov_b32 v49, 0
  v_mov_b32 v50, 0
  v_mov_b32 v51, 0
  v_mov_b32 v52, 0
  v_mov_b32 v53, 0
  v_mov_b32 v54, 0
  v_mov_b32 v55, 0
  v_mov_b32 v56, 0
  v_mov_b32 v57, 0
  v_mov_b32 v58, 0
  v_mov_b32 v59, 0
  v_mov_b32 v60, 0
  v_mov_b32 v61, 0
  v_mov_b32 v62, 0
  v_mov_b32 v63, 0
  v_mov_b32 v172, 0
  v_mov_b32 v173, 0
  v_mov_b32 v174, 0
  v_mov_b32 v175, 0
  s_waitcnt lgkmcnt(0)
  s_add_u32 s8, s8, 4194304
  s_addc_u32 s9, s9, 0
  s_mov_b32 s10, 12582912
  s_mov_b32 s11, 0x00020000
  s_add_u32 s12, s12, 16777216
  s_addc_u32 s13, s13, 0
  s_mov_b32 s14, 4194304
  s_mov_b32 s15, 0x00020000
  s_mov_b32 s36, s3
  s_load_dwordx2 s[20:21], s[0:1], 16
  s_load_dwordx2 s[22:23], s[0:1], 48
  s_load_dwordx2 s[24:25], s[0:1], 32
  s_waitcnt lgkmcnt(0)
  s_sub_u32 s43, 7, s36
  s_lshl_b32 s43, s43, 8
  s_add_u32 s43, s43, s2
  v_lshlrev_b32 v240, 7, v0
  s_mov_b32 s19, 0x00020000
  s_cmp_lt_u32 s43, 256
  s_cbranch_scc0 attL_pf1
  s_mov_b32 s16, s20
  s_mov_b32 s17, s21
  s_mov_b32 s18, 2097152
  s_branch attL_pf3
attL_pf1:
  s_sub_u32 s43, s43, 256
  s_cmp_lt_u32 s43, 896
  s_cbranch_scc0 attL_pf2
  s_mov_b32 s16, s24
  s_mov_b32 s17, s25
  s_mov_b32 s18, 7340032
  s_branch attL_pf3
attL_pf2:
  s_sub_u32 s43, s43, 896
  s_mov_b32 s16, s22
  s_mov_b32 s17, s23
  s_mov_b32 s18, 7340032
attL_pf3:
  s_lshl_b32 s51, s43, 13
  s_cmp_lg_u32 s3, 5
  s_cbranch_scc1 npf_wo
  s_getpc_b64 s[52:53]
pc_wo:
  s_sub_u32 s52, s52, pc_wo-C_wo
  s_subb_u32 s53, s53, 0
  v_lshlrev_b32 v246, 7, v0
  v_min_u32 v247, C_w1-C_wo-4, v246
  global_load_dword v248, v247, s[52:53]
npf_wo:
  s_cmp_lg_u32 s3, 4
  s_cbranch_scc1 L_q1
  s_lshr_b32 s44, s37, 1
  s_mul_i32 s43, s44, 4096
  s_add_u32 s43, s43, 0
  v_min_u32 v2, 15, v0
  v_mul_u32_u24 v2, 128, v2
  v_add_u32 v2, s43, v2
  s_mov_b32 s43, 0x8000
  s_waitcnt vmcnt(0)
  buffer_load_dword v252, v2, s[4:7], 0 offen sc0 sc1
  s_nop 15
  s_nop 15
  buffer_load_dword v253, v2, s[4:7], 0 offen sc0 sc1
  s_nop 15
  s_nop 15
L_p1:
  buffer_load_dword v254, v2, s[4:7], 0 offen sc0 sc1
  s_waitcnt vmcnt(2)
  v_cmp_ne_u32 vcc, s33, v252
  s_nop 4
  s_cbranch_vccz L_p1_x
  buffer_load_dword v252, v2, s[4:7], 0 offen sc0 sc1
  s_waitcnt vmcnt(2)
  v_cmp_ne_u32 vcc, s33, v253
  s_nop 4
  s_cbranch_vccz L_p1_x
  buffer_load_dword v253, v2, s[4:7], 0 offen sc0 sc1
  s_waitcnt vmcnt(2)
  v_cmp_ne_u32 vcc, s33, v254
  s_nop 4
  s_cbranch_vccz L_p1_x
  s_sub_u32 s43, s43, 1
  s_cmp_lg_u32 s43, 0
  s_cbranch_scc1 L_p1
L_p1_x:
  s_waitcnt vmcnt(0)
L_q1:
  s_branch att_dep
L_wo:
  s_cmp_lg_u32 s3, 5
  s_cbranch_scc1 npf_w1
  s_getpc_b64 s[52:53]
pc_w1:
  s_sub_u32 s52, s52, pc_w1-C_w1
  s_subb_u32 s53, s53, 0
  v_lshlrev_b32 v57, 7, v0
  v_min_u32 v58, C_w2-C_w1-4, v57
  global_load_dword v59, v58, s[52:53]
  v_add_u32 v57, 8192, v57
  v_min_u32 v58, C_w2-C_w1-4, v57
  global_load_dword v59, v58, s[52:53]
npf_w1:
  s_load_dwordx2 s[12:13], s[0:1], 16
  s_load_dwordx2 s[20:21], s[0:1], 0
  s_and_b32 s43, s2, 7
  s_lshr_b32 s44, s2, 3
  s_and_b32 s37, s43, 3
  s_mul_i32 s37, s37, 4
  s_and_b32 s45, s44, 3
  s_add_u32 s37, s37, s45
  s_lshr_b32 s38, s43, 2
  s_mul_i32 s38, s38, 8
  s_lshr_b32 s45, s44, 2
  s_add_u32 s38, s38, s45
  s_sub_u32 s43, s3, 4
  v_lshrrev_b32 v40, 5, v0
  v_bfe_u32 v41, v0, 2, 2
  v_lshl_add_u32 v41, v40, 2, v41
  v_lshlrev_b32 v41, 11, v41
  v_bfe_u32 v42, v0, 4, 1
  v_lshl_add_u32 v41, v42, 6, v41
  v_and_b32 v42, 3, v0
  v_lshlrev_b32 v40, 1, v40
  v_xor_b32 v42, v42, v40
  v_lshl_add_u32 v41, v42, 4, v41
  s_lshl_b32 s44, s38, 7
  v_add_u32 v8, s44, v41
  s_lshl_b32 s46, s43, 10
  s_lshl_b32 s47, s43, 14
  s_lshl_b32 s44, s37, 7
  s_lshl_b32 s45, s43, 5
  s_add_u32 s44, s44, s45
  s_lshl_b32 s44, s44, 11
  s_lshl_b32 s45, s38, 7
  s_add_u32 s44, s44, s45
  v_lshrrev_b32 v50, 3, v0
  v_lshl_add_u32 v50, v50, 11, s44
  v_lshrrev_b32 v51, 4, v0
  v_and_b32 v52, 7, v0
  v_xor_b32 v53, v52, v51
  v_lshl_add_u32 v9, v53, 4, v50
  v_xor_b32 v53, 4, v53
  v_lshl_add_u32 v10, v53, 4, v50
  s_lshl_b32 s48, s43, 12
  s_waitcnt lgkmcnt(0)
  s_mov_b32 s14, 2097152
  s_mov_b32 s15, 0x00020000
  s_mov_b32 s22, 4194304
  s_mov_b32 s23, 0x00020000
  s_mov_b32 s40, 8
wo_lw:
  s_mov_b32 m0, s46
  s_add_u32 s46, s46, 4096
  buffer_load_dwordx4 v8, s[12:15], s47 offen lds
  s_add_u32 s47, s47, 65536
  s_sub_u32 s40, s40, 1
  s_cmp_lg_u32 s40, 0
  s_cbranch_scc1 wo_lw
  s_barrier
  s_cmp_lg_u32 s3, 4
  s_cbranch_scc1 L_s2
  s_and_b32 s43, s2, 7
  s_lshr_b32 s44, s2, 3
  s_lshl_b32 s37, s43, 2
  s_lshr_b32 s45, s44, 3
  s_add_u32 s37, s37, s45
  s_and_b32 s38, s44, 7
  s_mul_i32 s43, s38, 4096
  s_mul_i32 s50, s37, 128
  s_add_u32 s43, s43, s50
  s_add_u32 s43, s43, 65536
  v_mov_b32 v2, s43
  v_mov_b32 v3, s33
  s_mov_b64 s[50:51], exec
  s_mov_b64 exec, 1
  buffer_store_dword v3, v2, s[4:7], 0 offen sc0 sc1
  s_mov_b64 exec, s[50:51]
  s_and_b32 s43, s2, 7
  s_lshr_b32 s44, s2, 3
  s_and_b32 s37, s43, 3
  s_mul_i32 s37, s37, 4
  s_and_b32 s45, s44, 3
  s_add_u32 s37, s37, s45
  s_lshr_b32 s38, s43, 2
  s_mul_i32 s38, s38, 8
  s_lshr_b32 s45, s44, 2
  s_add_u32 s38, s38, s45
L_s2:
  s_mov_b32 s40, 24
wo_lw2:
  s_mov_b32 m0, s46
  s_add_u32 s46, s46, 4096
  buffer_load_dwordx4 v8, s[12:15], s47 offen lds
  s_add_u32 s47, s47, 65536
  s_sub_u32 s40, s40, 1
  s_cmp_lg_u32 s40, 0
  s_cbranch_scc1 wo_lw2
  s_add_u32 m0, s48, 131072
  s_mov_b32 s44, 0
  buffer_load_dwordx4 v9, s[20:23], s44 offen lds
  s_add_u32 m0, m0, 1024
  s_add_u32 s44, s44, 16384
  buffer_load_dwordx4 v10, s[20:23], s44 offen lds
  s_add_u32 m0, m0, 1024
  s_add_u32 s44, s44, 16384
  buffer_load_dwordx4 v9, s[20:23], s44 offen lds
  s_add_u32 m0, m0, 1024
  s_add_u32 s44, s44, 16384
  buffer_load_dwordx4 v10, s[20:23], s44 offen lds
  s_add_u32 m0, m0, 1024
  s_add_u32 s44, s44, 16384
  s_waitcnt vmcnt(0)
  s_cmp_lg_u32 s3, 4
  s_cbranch_scc1 L_p2_o
  s_lshr_b32 s44, s37, 1
  s_mul_i32 s45, s44, 4096
  s_add_u32 s45, s45, 65536
  v_min_u32 v2, 31, v0
  v_mul_u32_u24 v2, 128, v2
  v_add_u32 v2, s45, v2
  s_mov_b32 s45, 0x8000
  s_waitcnt vmcnt(0)
  buffer_load_dword v252, v2, s[4:7], 0 offen sc0 sc1
  s_nop 15
  s_nop 15
  buffer_load_dword v253, v2, s[4:7], 0 offen sc0 sc1
  s_nop 15
  s_nop 15
L_p2:
  buffer_load_dword v254, v2, s[4:7], 0 offen sc0 sc1
  s_waitcnt vmcnt(2)
  v_cmp_ne_u32 vcc, s33, v252
  s_nop 4
  s_cbranch_vccz L_p2_x
  buffer_load_dword v252, v2, s[4:7], 0 offen sc0 sc1
  s_waitcnt vmcnt(2)
  v_cmp_ne_u32 vcc, s33, v253
  s_nop 4
  s_cbranch_vccz L_p2_x
  buffer_load_dword v253, v2, s[4:7], 0 offen sc0 sc1
  s_waitcnt vmcnt(2)
  v_cmp_ne_u32 vcc, s33, v254
  s_nop 4
  s_cbranch_vccz L_p2_x
  s_sub_u32 s45, s45, 1
  s_cmp_lg_u32 s45, 0
  s_cbranch_scc1 L_p2
L_p2_x:
  s_waitcnt vmcnt(0)
L_p2_o:
  s_barrier
  s_barrier
L_w1:
  s_cmp_lg_u32 s3, 5
  s_cbranch_scc1 npf_w2
  s_getpc_b64 s[52:53]
pc_w2:
  s_sub_u32 s52, s52, pc_w2-C_w2
  s_subb_u32 s53, s53, 0
  v_lshlrev_b32 v57, 7, v0
  v_min_u32 v58, L_stream-C_w2-4, v57
  global_load_dword v59, v58, s[52:53]
npf_w2:
  s_load_dwordx2 s[8:9], s[0:1], 80
  s_load_dwordx2 s[12:13], s[0:1], 32
  s_load_dwordx2 s[16:17], s[0:1], 80
  s_load_dwordx2 s[20:21], s[0:1], 80
  s_load_dwordx2 s[24:25], s[0:1], 40
  s_and_b32 s43, s2, 7
  s_lshr_b32 s44, s2, 3
  s_and_b32 s37, s43, 1
  s_mul_i32 s37, s37, 8
  s_and_b32 s45, s44, 7
  s_add_u32 s37, s37, s45
  s_lshr_b32 s38, s43, 1
  s_mul_i32 s38, s38, 4
  s_lshr_b32 s45, s44, 3
  s_add_u32 s38, s38, s45
  s_sub_u32 s43, s3, 4
  s_lshl_b32 s44, s37, 3
  s_mul_i32 s45, s43, 2
  s_add_u32 s44, s44, s45
  s_mul_i32 s44, s44, 32768
  v_lshl_add_u32 v8, v0, 4, s44
  v_add_u32 v9, 32768, v8
  v_lshrrev_b32 v40, 4, v0
  s_mul_i32 s44, s43, 28
  v_add_u32 v40, s44, v40
  v_bfe_u32 v41, v0, 2, 2
  v_and_b32 v42, 3, v0
  s_mov_b32 s45, 7168
  s_mul_i32 s44, s38, 448
  v_add_u32 v43, 0, v40
  v_mul_u32_u24 v44, 147, v43
  v_lshrrev_b32 v44, 10, v44
  v_mul_u32_u24 v45, 7, v44
  v_sub_u32 v45, v43, v45
  v_bfe_u32 v46, v44, 0, 1
  v_lshlrev_b32 v46, 1, v46
  v_xor_b32 v46, v46, v42
  v_lshl_add_u32 v46, v46, 4, s44
  v_lshl_add_u32 v44, v44, 2, v41
  v_mul_lo_u32 v44, v44, s45
  v_lshlrev_b32 v45, 6, v45
  v_add3_u32 v10, v44, v45, v46
  v_add_u32 v43, 4, v40
  v_mul_u32_u24 v44, 147, v43
  v_lshrrev_b32 v44, 10, v44
  v_mul_u32_u24 v45, 7, v44
  v_sub_u32 v45, v43, v45
  v_bfe_u32 v46, v44, 0, 1
  v_lshlrev_b32 v46, 1, v46
  v_xor_b32 v46, v46, v42
  v_lshl_add_u32 v46, v46, 4, s44
  v_lshl_add_u32 v44, v44, 2, v41
  v_mul_lo_u32 v44, v44, s45
  v_lshlrev_b32 v45, 6, v45
  v_add3_u32 v11, v44, v45, v46
  v_add_u32 v43, 8, v40
  v_mul_u32_u24 v44, 147, v43
  v_lshrrev_b32 v44, 10, v44
  v_mul_u32_u24 v45, 7, v44
  v_sub_u32 v45, v43, v45
  v_bfe_u32 v46, v44, 0, 1
  v_lshlrev_b32 v46, 1, v46
  v_xor_b32 v46, v46, v42
  v_lshl_add_u32 v46, v46, 4, s44
  v_lshl_add_u32 v44, v44, 2, v41
  v_mul_lo_u32 v44, v44, s45
  v_lshlrev_b32 v45, 6, v45
  v_add3_u32 v12, v44, v45, v46
  v_add_u32 v43, 12, v40
  v_mul_u32_u24 v44, 147, v43
  v_lshrrev_b32 v44, 10, v44
  v_mul_u32_u24 v45, 7, v44
  v_sub_u32 v45, v43, v45
  v_bfe_u32 v46, v44, 0, 1
  v_lshlrev_b32 v46, 1, v46
  v_xor_b32 v46, v46, v42
  v_lshl_add_u32 v46, v46, 4, s44
  v_lshl_add_u32 v44, v44, 2, v41
  v_mul_lo_u32 v44, v44, s45
  v_lshlrev_b32 v45, 6, v45
  v_add3_u32 v13, v44, v45, v46
  v_add_u32 v43, 16, v40
  v_mul_u32_u24 v44, 147, v43
  v_lshrrev_b32 v44, 10, v44
  v_mul_u32_u24 v45, 7, v44
  v_sub_u32 v45, v43, v45
  v_bfe_u32 v46, v44, 0, 1
  v_lshlrev_b32 v46, 1, v46
  v_xor_b32 v46, v46, v42
  v_lshl_add_u32 v46, v46, 4, s44
  v_lshl_add_u32 v44, v44, 2, v41
  v_mul_lo_u32 v44, v44, s45
  v_lshlrev_b32 v45, 6, v45
  v_add3_u32 v14, v44, v45, v46
  v_add_u32 v43, 20, v40
  v_mul_u32_u24 v44, 147, v43
  v_lshrrev_b32 v44, 10, v44
  v_mul_u32_u24 v45, 7, v44
  v_sub_u32 v45, v43, v45
  v_bfe_u32 v46, v44, 0, 1
  v_lshlrev_b32 v46, 1, v46
  v_xor_b32 v46, v46, v42
  v_lshl_add_u32 v46, v46, 4, s44
  v_lshl_add_u32 v44, v44, 2, v41
  v_mul_lo_u32 v44, v44, s45
  v_lshlrev_b32 v45, 6, v45
  v_add3_u32 v15, v44, v45, v46
  v_add_u32 v43, 24, v40
  v_mul_u32_u24 v44, 147, v43
  v_lshrrev_b32 v44, 10, v44
  v_mul_u32_u24 v45, 7, v44
  v_sub_u32 v45, v43, v45
  v_bfe_u32 v46, v44, 0, 1
  v_lshlrev_b32 v46, 1, v46
  v_xor_b32 v46, v46, v42
  v_lshl_add_u32 v46, v46, 4, s44
  v_lshl_add_u32 v44, v44, 2, v41
  v_mul_lo_u32 v44, v44, s45
  v_lshlrev_b32 v45, 6, v45
  v_add3_u32 v16, v44, v45, v46
  s_mul_i32 s46, s43, 4096
  s_mul_i32 s47, s43, 7168
  s_add_u32 s47, s47, 16384
  s_mov_b32 s41, 0
  s_mov_b32 s42, 0
  s_waitcnt lgkmcnt(0)
  s_add_u32 s8, s8, 20971520
  s_addc_u32 s9, s9, 0
  s_mov_b32 s10, 4194304
  s_mov_b32 s11, 0x00020000
  s_mov_b32 s14, 7340032
  s_mov_b32 s15, 0x00020000
  s_add_u32 s16, s16, 41943040
  s_addc_u32 s17, s17, 0
  s_mov_b32 s18, 262144
  s_mov_b32 s19, 0x00020000
  s_add_u32 s20, s20, 42991616
  s_addc_u32 s21, s21, 0
  s_mov_b32 s22, 229376
  s_mov_b32 s23, 0x00020000
  s_mov_b32 s26, 7168
  s_mov_b32 s27, 0x00020000
  s_mov_b32 s39, 0
  s_mov_b32 s40, 2
w1_lprw:
  s_add_u32 m0, s39, s47
  s_nop 0
  buffer_load_dwordx4 v10, s[12:15], s42 offen lds
  s_add_u32 m0, m0, 1024
  s_nop 0
  buffer_load_dwordx4 v11, s[12:15], s42 offen lds
  s_add_u32 m0, m0, 1024
  s_nop 0
  buffer_load_dwordx4 v12, s[12:15], s42 offen lds
  s_add_u32 m0, m0, 1024
  s_nop 0
  buffer_load_dwordx4 v13, s[12:15], s42 offen lds
  s_add_u32 m0, m0, 1024
  s_nop 0
  buffer_load_dwordx4 v14, s[12:15], s42 offen lds
  s_add_u32 m0, m0, 1024
  s_nop 0
  buffer_load_dwordx4 v15, s[12:15], s42 offen lds
  s_add_u32 m0, m0, 1024
  s_nop 0
  buffer_load_dwordx4 v16, s[12:15], s42 offen lds
  s_add_u32 s42, s42, 458752
  s_add_u32 s39, s39, 45056
  s_sub_u32 s40, s40, 1
  s_cmp_lg_u32 s40, 0
  s_cbranch_scc1 w1_lprw
  s_barrier
  s_cmp_lg_u32 s3, 4
  s_cbranch_scc1 L_s3
  s_mov_b32 s48, s37
  s_mov_b32 s49, s38
  s_and_b32 s43, s2, 7
  s_lshr_b32 s44, s2, 3
  s_and_b32 s37, s43, 3
  s_mul_i32 s37, s37, 4
  s_and_b32 s45, s44, 3
  s_add_u32 s37, s37, s45
  s_lshr_b32 s38, s43, 2
  s_mul_i32 s38, s38, 8
  s_lshr_b32 s45, s44, 2
  s_add_u32 s38, s38, s45
  s_mul_i32 s43, s37, 4096
  s_mul_i32 s50, s38, 128
  s_add_u32 s43, s43, s50
  s_add_u32 s43, s43, 131072
  v_mov_b32 v2, s43
  v_mov_b32 v3, s33
  s_mov_b64 s[50:51], exec
  s_mov_b64 exec, 1
  buffer_store_dword v3, v2, s[4:7], 0 offen sc0 sc1
  s_mov_b64 exec, s[50:51]
  s_mov_b32 s37, s48
  s_mov_b32 s38, s49
L_s3:
  s_cmp_lg_u32 s3, 4
  s_cbranch_scc1 L_s5
  s_and_b32 s48, s2, 15
  s_lshr_b32 s49, s2, 4
  s_mul_i32 s43, s48, 4096
  s_mul_i32 s50, s49, 128
  s_add_u32 s43, s43, s50
  s_add_u32 s43, s43, 458752
  v_mov_b32 v2, s43
  v_mov_b32 v3, s33
  s_mov_b64 s[50:51], exec
  s_mov_b64 exec, 1
  buffer_store_dword v3, v2, s[4:7], 0 offen sc0 sc1
  s_mov_b64 exec, s[50:51]
L_s5:
  s_cmp_lg_u32 s3, 4
  s_cbranch_scc1 L_p3_o
  s_mov_b32 s44, s37
  s_mul_i32 s45, s44, 4096
  s_add_u32 s45, s45, 131072
  v_min_u32 v2, 15, v0
  v_mul_u32_u24 v2, 128, v2
  v_add_u32 v2, s45, v2
  s_mul_i32 s45, s38, 4096
  s_add_u32 s45, s45, 458752
  v_and_b32 v3, 15, v0
  v_mul_u32_u24 v3, 128, v3
  v_add_u32 v3, s45, v3
  v_cmp_gt_u32 vcc, 16, v0
  s_nop 1
  v_cndmask_b32 v2, v3, v2, vcc
  s_mov_b32 s45, 0x8000
  s_waitcnt vmcnt(0)
  buffer_load_dword v252, v2, s[4:7], 0 offen sc0 sc1
  s_nop 15
  s_nop 15
  buffer_load_dword v253, v2, s[4:7], 0 offen sc0 sc1
  s_nop 15
  s_nop 15
L_p3:
  buffer_load_dword v254, v2, s[4:7], 0 offen sc0 sc1
  s_waitcnt vmcnt(2)
  v_cmp_ne_u32 vcc, s33, v252
  s_nop 4
  s_cbranch_vccz L_p3_x
  buffer_load_dword v252, v2, s[4:7], 0 offen sc0 sc1
  s_waitcnt vmcnt(2)
  v_cmp_ne_u32 vcc, s33, v253
  s_nop 4
  s_cbranch_vccz L_p3_x
  buffer_load_dword v253, v2, s[4:7], 0 offen sc0 sc1
  s_waitcnt vmcnt(2)
  v_cmp_ne_u32 vcc, s33, v254
  s_nop 4
  s_cbranch_vccz L_p3_x
  s_sub_u32 s45, s45, 1
  s_cmp_lg_u32 s45, 0
  s_cbranch_scc1 L_p3
L_p3_x:
  s_waitcnt vmcnt(0)
L_p3_o:
  s_barrier
  s_mov_b32 s39, 0
  s_mov_b32 s40, 2
w1_lprm:
  s_add_u32 m0, s39, s46
  s_nop 0
  buffer_load_dwordx4 v8, s[8:11], s41 offen offset:0 lds
  buffer_load_dwordx4 v8, s[8:11], s41 offen offset:1024 lds
  s_add_u32 m0, m0, 2048
  s_nop 0
  buffer_load_dwordx4 v9, s[8:11], s41 offen offset:0 lds
  buffer_load_dwordx4 v9, s[8:11], s41 offen offset:1024 lds
  s_add_u32 s41, s41, 2048
  s_add_u32 s39, s39, 45056
  s_sub_u32 s40, s40, 1
  s_cmp_lg_u32 s40, 0
  s_cbranch_scc1 w1_lprm
  s_sub_u32 s48, s3, 4
  s_lshl_b32 s48, s48, 6
  v_add_u32 v60, s48, v0
  v_lshrrev_b32 v61, 2, v60
  v_and_b32 v62, 3, v60
  s_lshl_b32 s48, s37, 10
  v_lshl_add_u32 v63, v61, 4, s48
  v_lshl_add_u32 v63, v62, 16, v63
  s_mul_i32 s48, s38, 896
  v_lshl_add_u32 v64, v61, 4, s48
  v_mul_u32_u24 v66, 57344, v62
  v_add_u32 v64, v64, v66
  s_mul_i32 s48, s38, 448
  v_lshl_add_u32 v65, v60, 1, s48
  s_mov_b32 s48, 0
  buffer_load_dwordx4 v[104:107], v63, s[16:19], s48 offen
  s_mov_b32 s48, 16384
  buffer_load_dwordx4 v[108:111], v63, s[16:19], s48 offen
  s_mov_b32 s48, 32768
  buffer_load_dwordx4 v[112:115], v63, s[16:19], s48 offen
  s_mov_b32 s48, 49152
  buffer_load_dwordx4 v[116:119], v63, s[16:19], s48 offen
  s_mov_b32 s48, 0
  buffer_load_dwordx4 v[84:87], v64, s[20:23], s48 offen
  s_mov_b32 s48, 14336
  buffer_load_dwordx4 v[88:91], v64, s[20:23], s48 offen
  s_mov_b32 s48, 28672
  buffer_load_dwordx4 v[92:95], v64, s[20:23], s48 offen
  s_mov_b32 s48, 43008
  buffer_load_dwordx4 v[96:99], v64, s[20:23], s48 offen
  buffer_load_ushort v100, v65, s[24:27], 0 offen
  s_waitcnt vmcnt(13)
  s_barrier
  s_add_u32 m0, s39, s46
  s_nop 0
  buffer_load_dwordx4 v8, s[8:11], s41 offen offset:0 lds
  buffer_load_dwordx4 v8, s[8:11], s41 offen offset:1024 lds
  s_add_u32 m0, m0, 2048
  s_nop 0
  buffer_load_dwordx4 v9, s[8:11], s41 offen offset:0 lds
  buffer_load_dwordx4 v9, s[8:11], s41 offen offset:1024 lds
  s_add_u32 s41, s41, 2048
  s_add_u32 m0, s39, s47
  s_nop 0
  buffer_load_dwordx4 v10, s[12:15], s42 offen lds
  s_add_u32 m0, m0, 1024
  s_nop 0
  buffer_load_dwordx4 v11, s[12:15], s42 offen lds
  s_add_u32 m0, m0, 1024
  s_nop 0
  buffer_load_dwordx4 v12, s[12:15], s42 offen lds
  s_add_u32 m0, m0, 1024
  s_nop 0
  buffer_load_dwordx4 v13, s[12:15], s42 offen lds
  s_add_u32 m0, m0, 1024
  s_nop 0
  buffer_load_dwordx4 v14, s[12:15], s42 offen lds
  s_add_u32 m0, m0, 1024
  s_nop 0
  buffer_load_dwordx4 v15, s[12:15], s42 offen lds
  s_add_u32 m0, m0, 1024
  s_nop 0
  buffer_load_dwordx4 v16, s[12:15], s42 offen lds
  s_add_u32 s42, s42, 458752
  s_add_u32 s39, s39, 45056
  s_cmp_eq_u32 s39, 135168
  s_cselect_b32 s39, 0, s39
  s_waitcnt vmcnt(20)
  s_barrier
  s_add_u32 m0, s39, s46
  s_nop 0
  buffer_load_dwordx4 v8, s[8:11], s41 offen offset:0 lds
  buffer_load_dwordx4 v8, s[8:11], s41 offen offset:1024 lds
  s_add_u32 m0, m0, 2048
  s_nop 0
  buffer_load_dwordx4 v9, s[8:11], s41 offen offset:0 lds
  buffer_load_dwordx4 v9, s[8:11], s41 offen offset:1024 lds
  s_add_u32 s41, s41, 2048
  s_add_u32 m0, s39, s47
  s_nop 0
  buffer_load_dwordx4 v10, s[12:15], s42 offen lds
  s_add_u32 m0, m0, 1024
  s_nop 0
  buffer_load_dwordx4 v11, s[12:15], s42 offen lds
  s_add_u32 m0, m0, 1024
  s_nop 0
  buffer_load_dwordx4 v12, s[12:15], s42 offen lds
  s_add_u32 m0, m0, 1024
  s_nop 0
  buffer_load_dwordx4 v13, s[12:15], s42 offen lds
  s_add_u32 m0, m0, 1024
  s_nop 0
  buffer_load_dwordx4 v14, s[12:15], s42 offen lds
  s_add_u32 m0, m0, 1024
  s_nop 0
  buffer_load_dwordx4 v15, s[12:15], s42 offen lds
  s_add_u32 m0, m0, 1024
  s_nop 0
  buffer_load_dwordx4 v16, s[12:15], s42 offen lds
  s_add_u32 s42, s42, 458752
  s_add_u32 s39, s39, 45056
  s_cmp_eq_u32 s39, 135168
  s_cselect_b32 s39, 0, s39
  s_waitcnt vmcnt(22)
  v_pk_add_f32 v[84:85], v[84:85], v[88:89]
  v_pk_add_f32 v[86:87], v[86:87], v[90:91]
  v_pk_add_f32 v[84:85], v[84:85], v[92:93]
  v_pk_add_f32 v[86:87], v[86:87], v[94:95]
  v_pk_add_f32 v[84:85], v[84:85], v[96:97]
  v_pk_add_f32 v[86:87], v[86:87], v[98:99]
  v_pk_add_f32 v[104:105], v[104:105], v[108:109]
  v_pk_add_f32 v[106:107], v[106:107], v[110:111]
  v_pk_add_f32 v[104:105], v[104:105], v[112:113]
  v_pk_add_f32 v[106:107], v[106:107], v[114:115]
  v_pk_add_f32 v[104:105], v[104:105], v[116:117]
  v_pk_add_f32 v[106:107], v[106:107], v[118:119]
  s_nop 1
  v_add_f32_dpp v84, v84, v84 quad_perm:[1,0,3,2] row_mask:0xf bank_mask:0xf
  v_add_f32_dpp v85, v85, v85 quad_perm:[1,0,3,2] row_mask:0xf bank_mask:0xf
  v_add_f32_dpp v86, v86, v86 quad_perm:[1,0,3,2] row_mask:0xf bank_mask:0xf
  v_add_f32_dpp v87, v87, v87 quad_perm:[1,0,3,2] row_mask:0xf bank_mask:0xf
  v_add_f32_dpp v104, v104, v104 quad_perm:[1,0,3,2] row_mask:0xf bank_mask:0xf
  v_add_f32_dpp v105, v105, v105 quad_perm:[1,0,3,2] row_mask:0xf bank_mask:0xf
  v_add_f32_dpp v106, v106, v106 quad_perm:[1,0,3,2] row_mask:0xf bank_mask:0xf
  v_add_f32_dpp v107, v107, v107 quad_perm:[1,0,3,2] row_mask:0xf bank_mask:0xf
  v_add_f32_dpp v84, v84, v84 quad_perm:[2,3,0,1] row_mask:0xf bank_mask:0xf
  v_add_f32_dpp v85, v85, v85 quad_perm:[2,3,0,1] row_mask:0xf bank_mask:0xf
  v_add_f32_dpp v86, v86, v86 quad_perm:[2,3,0,1] row_mask:0xf bank_mask:0xf
  v_add_f32_dpp v87, v87, v87 quad_perm:[2,3,0,1] row_mask:0xf bank_mask:0xf
  v_add_f32_dpp v104, v104, v104 quad_perm:[2,3,0,1] row_mask:0xf bank_mask:0xf
  v_add_f32_dpp v105, v105, v105 quad_perm:[2,3,0,1] row_mask:0xf bank_mask:0xf
  v_add_f32_dpp v106, v106, v106 quad_perm:[2,3,0,1] row_mask:0xf bank_mask:0xf
  v_add_f32_dpp v107, v107, v107 quad_perm:[2,3,0,1] row_mask:0xf bank_mask:0xf
  v_lshlrev_b32 v100, 16, v100
  v_lshlrev_b32 v66, 2, v60
  v_add_u32 v66, 137088, v66
  v_lshlrev_b32 v67, 4, v61
  v_add_u32 v67, 136192, v67
  v_cmp_gt_u32 vcc, 224, v60
  s_and_saveexec_b64 s[48:49], vcc
  s_cbranch_execz w1_ncs
  ds_write_b32 v66, v100
  ds_write_b128 v67, v[84:87]
w1_ncs:
  s_mov_b64 exec, s[48:49]
  v_mul_f32 v104, 0x3a800000, v104
  v_mul_f32 v105, 0x3a800000, v105
  v_fma_f32 v105, -v104, v104, v105
  v_add_f32 v105, 0x3727c5ac, v105
  v_mul_f32 v106, 0x3a800000, v106
  v_mul_f32 v107, 0x3a800000, v107
  v_fma_f32 v107, -v106, v106, v107
  v_add_f32 v107, 0x3727c5ac, v107
  v_rsq_f32 v70, v105
  v_rsq_f32 v72, v107
  s_nop 0
  v_mul_f32 v71, v104, v70
  v_mul_f32 v73, v106, v72
  v_sub_f32 v71, 0, v71
  v_sub_f32 v73, 0, v73
  v_lshlrev_b32 v66, 4, v61
  v_add_u32 v66, 135168, v66
  ds_write_b128 v66, v[70:73]
  s_waitcnt lgkmcnt(0)
  s_mov_b32 s40, 12
w1_lmain:
  s_waitcnt vmcnt(11)
  s_barrier
  s_add_u32 m0, s39, s46
  s_nop 0
  buffer_load_dwordx4 v8, s[8:11], s41 offen offset:0 lds
  buffer_load_dwordx4 v8, s[8:11], s41 offen offset:1024 lds
  s_add_u32 m0, m0, 2048
  s_nop 0
  buffer_load_dwordx4 v9, s[8:11], s41 offen offset:0 lds
  buffer_load_dwordx4 v9, s[8:11], s41 offen offset:1024 lds
  s_add_u32 s41, s41, 2048
  s_add_u32 m0, s39, s47
  s_nop 0
  buffer_load_dwordx4 v10, s[12:15], s42 offen lds
  s_add_u32 m0, m0, 1024
  s_nop 0
  buffer_load_dwordx4 v11, s[12:15], s42 offen lds
  s_add_u32 m0, m0, 1024
  s_nop 0
  buffer_load_dwordx4 v12, s[12:15], s42 offen lds
  s_add_u32 m0, m0, 1024
  s_nop 0
  buffer_load_dwordx4 v13, s[12:15], s42 offen lds
  s_add_u32 m0, m0, 1024
  s_nop 0
  buffer_load_dwordx4 v14, s[12:15], s42 offen lds
  s_add_u32 m0, m0, 1024
  s_nop 0
  buffer_load_dwordx4 v15, s[12:15], s42 offen lds
  s_add_u32 m0, m0, 1024
  s_nop 0
  buffer_load_dwordx4 v16, s[12:15], s42 offen lds
  s_add_u32 s42, s42, 458752
  s_add_u32 s39, s39, 45056
  s_cmp_eq_u32 s39, 135168
  s_cselect_b32 s39, 0, s39
  s_sub_u32 s40, s40, 1
  s_cmp_lg_u32 s40, 0
  s_cbranch_scc1 w1_lmain
  s_waitcnt vmcnt(11)
  s_barrier
  s_waitcnt vmcnt(0)
  s_barrier
  s_barrier
L_w2:
  s_load_dwordx2 s[8:9], s[0:1], 80
  s_load_dwordx2 s[12:13], s[0:1], 48
  s_bfe_u32 s36, s2, 0x10002
  s_and_b32 s37, s2, 1
  s_lshl_b32 s37, s37, 3
  s_bfe_u32 s43, s2, 0x30003
  s_add_u32 s37, s37, s43
  s_bfe_u32 s38, s2, 0x10001
  s_lshl_b32 s38, s38, 2
  s_lshr_b32 s43, s2, 6
  s_add_u32 s38, s38, s43
  s_sub_u32 s43, s3, 4
  s_lshl_b32 s44, s37, 3
  s_mul_i32 s45, s43, 2
  s_add_u32 s44, s44, s45
  s_mul_i32 s44, s44, 114688
  v_lshl_add_u32 v8, v0, 4, s44
  v_add_u32 v9, 114688, v8
  v_lshrrev_b32 v40, 4, v0
  s_mul_i32 s44, s43, 16
  v_add_u32 v40, s44, v40
  v_bfe_u32 v41, v0, 2, 2
  v_and_b32 v42, 3, v0
  s_mov_b32 s45, 2048
  s_lshl_b32 s44, s38, 8
  v_add_u32 v43, 0, v40
  v_mul_u32_u24 v44, 4, v43
  v_lshrrev_b32 v44, 4, v44
  v_mul_u32_u24 v45, 4, v44
  v_sub_u32 v45, v43, v45
  v_and_b32 v46, 1, v44
  v_lshlrev_b32 v46, 1, v46
  v_xor_b32 v46, v46, v42
  v_lshl_add_u32 v46, v46, 4, s44
  v_and_b32 v44, 7, v44
  v_lshl_add_u32 v44, v44, 2, v41
  v_mul_lo_u32 v44, v44, s45
  v_lshlrev_b32 v45, 6, v45
  v_add3_u32 v10, v44, v45, v46
  v_add_u32 v43, 4, v40
  v_mul_u32_u24 v44, 4, v43
  v_lshrrev_b32 v44, 4, v44
  v_mul_u32_u24 v45, 4, v44
  v_sub_u32 v45, v43, v45
  v_and_b32 v46, 1, v44
  v_lshlrev_b32 v46, 1, v46
  v_xor_b32 v46, v46, v42
  v_lshl_add_u32 v46, v46, 4, s44
  v_and_b32 v44, 7, v44
  v_lshl_add_u32 v44, v44, 2, v41
  v_mul_lo_u32 v44, v44, s45
  v_lshlrev_b32 v45, 6, v45
  v_add3_u32 v11, v44, v45, v46
  v_add_u32 v43, 8, v40
  v_mul_u32_u24 v44, 4, v43
  v_lshrrev_b32 v44, 4, v44
  v_mul_u32_u24 v45, 4, v44
  v_sub_u32 v45, v43, v45
  v_and_b32 v46, 1, v44
  v_lshlrev_b32 v46, 1, v46
  v_xor_b32 v46, v46, v42
  v_lshl_add_u32 v46, v46, 4, s44
  v_and_b32 v44, 7, v44
  v_lshl_add_u32 v44, v44, 2, v41
  v_mul_lo_u32 v44, v44, s45
  v_lshlrev_b32 v45, 6, v45
  v_add3_u32 v12, v44, v45, v46
  v_add_u32 v43, 12, v40
  v_mul_u32_u24 v44, 4, v43
  v_lshrrev_b32 v44, 4, v44
  v_mul_u32_u24 v45, 4, v44
  v_sub_u32 v45, v43, v45
  v_and_b32 v46, 1, v44
  v_lshlrev_b32 v46, 1, v46
  v_xor_b32 v46, v46, v42
  v_lshl_add_u32 v46, v46, 4, s44
  v_and_b32 v44, 7, v44
  v_lshl_add_u32 v44, v44, 2, v41
  v_mul_lo_u32 v44, v44, s45
  v_lshlrev_b32 v45, 6, v45
  v_add3_u32 v13, v44, v45, v46
  s_mul_i32 s46, s43, 4096
  s_mul_i32 s47, s43, 4096
  s_add_u32 s47, s47, 16384
  s_mul_i32 s41, s36, 57344
  s_mul_i32 s42, s36, 3670016
  s_mul_i32 s32, s38, 7
  s_lshr_b32 s31, s43, 1
  s_mov_b32 s34, s31
  s_mov_b32 s35, 0
  s_waitcnt lgkmcnt(0)
  s_add_u32 s8, s8, 25165824
  s_addc_u32 s9, s9, 0
  s_mov_b32 s10, 14680064
  s_mov_b32 s11, 0x00020000
  s_mov_b32 s14, 7340032
  s_mov_b32 s15, 0x00020000
  s_add_u32 s45, s32, s31
  s_add_u32 s45, s45, 0
  s_mul_i32 s45, s45, 65536
  s_add_u32 s45, s45, s42
  s_add_u32 m0, 0, s47
  s_nop 0
  buffer_load_dwordx4 v10, s[12:15], s45 offen lds
  s_add_u32 m0, m0, 1024
  s_nop 0
  buffer_load_dwordx4 v11, s[12:15], s45 offen lds
  s_add_u32 m0, m0, 1024
  s_nop 0
  buffer_load_dwordx4 v12, s[12:15], s45 offen lds
  s_add_u32 m0, m0, 1024
  s_nop 0
  buffer_load_dwordx4 v13, s[12:15], s45 offen lds
  s_add_u32 s45, s32, s31
  s_add_u32 s45, s45, 2
  s_mul_i32 s45, s45, 65536
  s_add_u32 s45, s45, s42
  s_add_u32 m0, 32768, s47
  s_nop 0
  buffer_load_dwordx4 v10, s[12:15], s45 offen lds
  s_add_u32 m0, m0, 1024
  s_nop 0
  buffer_load_dwordx4 v11, s[12:15], s45 offen lds
  s_add_u32 m0, m0, 1024
  s_nop 0
  buffer_load_dwordx4 v12, s[12:15], s45 offen lds
  s_add_u32 m0, m0, 1024
  s_nop 0
  buffer_load_dwordx4 v13, s[12:15], s45 offen lds
  s_add_u32 s45, s32, s31
  s_add_u32 s45, s45, 4
  s_mul_i32 s45, s45, 65536
  s_add_u32 s45, s45, s42
  s_add_u32 m0, 65536, s47
  s_nop 0
  buffer_load_dwordx4 v10, s[12:15], s45 offen lds
  s_add_u32 m0, m0, 1024
  s_nop 0
  buffer_load_dwordx4 v11, s[12:15], s45 offen lds
  s_add_u32 m0, m0, 1024
  s_nop 0
  buffer_load_dwordx4 v12, s[12:15], s45 offen lds
  s_add_u32 m0, m0, 1024
  s_nop 0
  buffer_load_dwordx4 v13, s[12:15], s45 offen lds
  s_barrier
  s_cmp_lg_u32 s3, 4
  s_cbranch_scc1 L_s4
  s_lshl_b32 s52, s36, 3
  s_add_u32 s52, s52, s38
  s_mul_i32 s43, s37, 4096
  s_mul_i32 s50, s52, 128
  s_add_u32 s43, s43, s50
  s_add_u32 s43, s43, 196608
  v_mov_b32 v2, s43
  v_mov_b32 v3, s33
  s_mov_b64 s[50:51], exec
  s_mov_b64 exec, 1
  buffer_store_dword v3, v2, s[4:7], 0 offen sc0 sc1
  s_mov_b64 exec, s[50:51]
L_s4:
  s_mov_b32 s44, s37
  s_lshl_b32 s52, s36, 3
  s_mul_i32 s45, s44, 4096
  s_add_u32 s45, s45, 196608
  v_min_u32 v2, 7, v0
  v_add_u32 v2, s52, v2
  v_mul_u32_u24 v2, 128, v2
  v_add_u32 v2, s45, v2
  s_waitcnt vmcnt(8)
  s_barrier
  s_cmp_ge_u32 s34, s32
  s_cselect_b32 s45, 6, 0
  s_add_u32 s45, s45, s34
  s_add_u32 s34, s34, 2
  s_mul_i32 s45, s45, 65536
  s_add_u32 s45, s45, s42
  s_add_u32 m0, 98304, s47
  s_nop 0
  buffer_load_dwordx4 v10, s[12:15], s45 offen lds
  s_add_u32 m0, m0, 1024
  s_nop 0
  buffer_load_dwordx4 v11, s[12:15], s45 offen lds
  s_add_u32 m0, m0, 1024
  s_nop 0
  buffer_load_dwordx4 v12, s[12:15], s45 offen lds
  s_add_u32 m0, m0, 1024
  s_nop 0
  buffer_load_dwordx4 v13, s[12:15], s45 offen lds
  s_waitcnt vmcnt(8)
  s_barrier
  s_cmp_ge_u32 s34, s32
  s_cselect_b32 s45, 6, 0
  s_add_u32 s45, s45, s34
  s_add_u32 s34, s34, 2
  s_mul_i32 s45, s45, 65536
  s_add_u32 s45, s45, s42
  s_add_u32 m0, 0, s47
  s_nop 0
  buffer_load_dwordx4 v10, s[12:15], s45 offen lds
  s_add_u32 m0, m0, 1024
  s_nop 0
  buffer_load_dwordx4 v11, s[12:15], s45 offen lds
  s_add_u32 m0, m0, 1024
  s_nop 0
  buffer_load_dwordx4 v12, s[12:15], s45 offen lds
  s_add_u32 m0, m0, 1024
  s_nop 0
  buffer_load_dwordx4 v13, s[12:15], s45 offen lds
  s_cmp_lg_u32 s3, 4
  s_cbranch_scc1 L_pi1
  buffer_load_dword v252, v2, s[4:7], 0 offen sc0 sc1
L_pi1:
  s_waitcnt vmcnt(8)
  s_barrier
  s_cmp_lg_u32 s3, 4
  s_cbranch_scc1 L_pi2
  buffer_load_dword v253, v2, s[4:7], 0 offen sc0 sc1
L_pi2:
  v_mov_b32 v4, 147200
  s_xor_b32 s53, s33, 0x5a5a5a5a
  s_cmp_lg_u32 s3, 4
  s_cbranch_scc1 L_p4_w
  s_mov_b32 s45, 0x8000
L_p4:
  buffer_load_dword v254, v2, s[4:7], 0 offen sc0 sc1
  s_waitcnt vmcnt(2)
  v_cmp_ne_u32 vcc, s33, v252
  s_nop 4
  s_cbranch_vccz L_p4_x
  buffer_load_dword v252, v2, s[4:7], 0 offen sc0 sc1
  s_waitcnt vmcnt(2)
  v_cmp_ne_u32 vcc, s33, v253
  s_nop 4
  s_cbranch_vccz L_p4_x
  buffer_load_dword v253, v2, s[4:7], 0 offen sc0 sc1
  s_waitcnt vmcnt(2)
  v_cmp_ne_u32 vcc, s33, v254
  s_nop 4
  s_cbranch_vccz L_p4_x
  s_sub_u32 s45, s45, 1
  s_cmp_lg_u32 s45, 0
  s_cbranch_scc1 L_p4
L_p4_x:
  s_waitcnt vmcnt(0)
  v_mov_b32 v5, s53
  ds_write_b32 v4, v5
  s_waitcnt lgkmcnt(0)
  s_branch L_p4_d
L_p4_w:
  s_mov_b32 s45, 0x100000
L_p4_l:
  ds_read_b32 v5, v4
  s_sub_u32 s45, s45, 1
  s_cmp_eq_u32 s45, 0
  s_cbranch_scc1 L_p4_d
  s_waitcnt lgkmcnt(0)
  v_cmp_ne_u32 vcc, s53, v5
  s_nop 4
  s_cbranch_vccnz L_p4_l
L_p4_d:
  s_waitcnt vmcnt(0) lgkmcnt(0)
  s_cmp_ge_u32 s35, s32
  s_cselect_b32 s48, 6, 0
  s_add_u32 s48, s48, s35
  s_lshl_b32 s48, s48, 10
  s_add_u32 s48, s48, s41
  s_add_u32 s35, s35, 1
  s_cmp_ge_u32 s35, s32
  s_cselect_b32 s49, 6, 0
  s_add_u32 s49, s49, s35
  s_lshl_b32 s49, s49, 10
  s_add_u32 s49, s49, s41
  s_add_u32 s35, s35, 1
  s_add_u32 m0, 98304, s46
  s_nop 0
  buffer_load_dwordx4 v8, s[8:11], s48 offen lds
  s_add_u32 m0, m0, 1024
  s_nop 0
  buffer_load_dwordx4 v8, s[8:11], s49 offen lds
  s_add_u32 m0, m0, 1024
  s_nop 0
  buffer_load_dwordx4 v9, s[8:11], s48 offen lds
  s_add_u32 m0, m0, 1024
  s_nop 0
  buffer_load_dwordx4 v9, s[8:11], s49 offen lds
  s_cmp_ge_u32 s35, s32
  s_cselect_b32 s48, 6, 0
  s_add_u32 s48, s48, s35
  s_lshl_b32 s48, s48, 10
  s_add_u32 s48, s48, s41
  s_add_u32 s35, s35, 1
  s_cmp_ge_u32 s35, s32
  s_cselect_b32 s49, 6, 0
  s_add_u32 s49, s49, s35
  s_lshl_b32 s49, s49, 10
  s_add_u32 s49, s49, s41
  s_add_u32 s35, s35, 1
  s_add_u32 m0, 0, s46
  s_nop 0
  buffer_load_dwordx4 v8, s[8:11], s48 offen lds
  s_add_u32 m0, m0, 1024
  s_nop 0
  buffer_load_dwordx4 v8, s[8:11], s49 offen lds
  s_add_u32 m0, m0, 1024
  s_nop 0
  buffer_load_dwordx4 v9, s[8:11], s48 offen lds
  s_add_u32 m0, m0, 1024
  s_nop 0
  buffer_load_dwordx4 v9, s[8:11], s49 offen lds
  s_cmp_ge_u32 s35, s32
  s_cselect_b32 s48, 6, 0
  s_add_u32 s48, s48, s35
  s_lshl_b32 s48, s48, 10
  s_add_u32 s48, s48, s41
  s_add_u32 s35, s35, 1
  s_cmp_ge_u32 s35, s32
  s_cselect_b32 s49, 6, 0
  s_add_u32 s49, s49, s35
  s_lshl_b32 s49, s49, 10
  s_add_u32 s49, s49, s41
  s_add_u32 s35, s35, 1
  s_add_u32 m0, 32768, s46
  s_nop 0
  buffer_load_dwordx4 v8, s[8:11], s48 offen lds
  s_add_u32 m0, m0, 1024
  s_nop 0
  buffer_load_dwordx4 v8, s[8:11], s49 offen lds
  s_add_u32 m0, m0, 1024
  s_nop 0
  buffer_load_dwordx4 v9, s[8:11], s48 offen lds
  s_add_u32 m0, m0, 1024
  s_nop 0
  buffer_load_dwordx4 v9, s[8:11], s49 offen lds
  s_cmp_ge_u32 s34, s32
  s_cselect_b32 s45, 6, 0
  s_add_u32 s45, s45, s34
  s_add_u32 s34, s34, 2
  s_mul_i32 s45, s45, 65536
  s_add_u32 s45, s45, s42
  s_add_u32 m0, 32768, s47
  s_nop 0
  buffer_load_dwordx4 v10, s[12:15], s45 offen lds
  s_add_u32 m0, m0, 1024
  s_nop 0
  buffer_load_dwordx4 v11, s[12:15], s45 offen lds
  s_add_u32 m0, m0, 1024
  s_nop 0
  buffer_load_dwordx4 v12, s[12:15], s45 offen lds
  s_add_u32 m0, m0, 1024
  s_nop 0
  buffer_load_dwordx4 v13, s[12:15], s45 offen lds
  s_waitcnt vmcnt(12)
  s_barrier
  s_cmp_ge_u32 s35, s32
  s_cselect_b32 s48, 6, 0
  s_add_u32 s48, s48, s35
  s_lshl_b32 s48, s48, 10
  s_add_u32 s48, s48, s41
  s_add_u32 s35, s35, 1
  s_cmp_ge_u32 s35, s32
  s_cselect_b32 s49, 6, 0
  s_add_u32 s49, s49, s35
  s_lshl_b32 s49, s49, 10
  s_add_u32 s49, s49, s41
  s_add_u32 s35, s35, 1
  s_add_u32 m0, 65536, s46
  s_nop 0
  buffer_load_dwordx4 v8, s[8:11], s48 offen lds
  s_add_u32 m0, m0, 1024
  s_nop 0
  buffer_load_dwordx4 v8, s[8:11], s49 offen lds
  s_add_u32 m0, m0, 1024
  s_nop 0
  buffer_load_dwordx4 v9, s[8:11], s48 offen lds
  s_add_u32 m0, m0, 1024
  s_nop 0
  buffer_load_dwordx4 v9, s[8:11], s49 offen lds
  s_cmp_ge_u32 s34, s32
  s_cselect_b32 s45, 6, 0
  s_add_u32 s45, s45, s34
  s_add_u32 s34, s34, 2
  s_mul_i32 s45, s45, 65536
  s_add_u32 s45, s45, s42
  s_add_u32 m0, 65536, s47
  s_nop 0
  buffer_load_dwordx4 v10, s[12:15], s45 offen lds
  s_add_u32 m0, m0, 1024
  s_nop 0
  buffer_load_dwordx4 v11, s[12:15], s45 offen lds
  s_add_u32 m0, m0, 1024
  s_nop 0
  buffer_load_dwordx4 v12, s[12:15], s45 offen lds
  s_add_u32 m0, m0, 1024
  s_nop 0
  buffer_load_dwordx4 v13, s[12:15], s45 offen lds
  s_waitcnt vmcnt(16)
  s_barrier
  s_cmp_ge_u32 s35, s32
  s_cselect_b32 s48, 6, 0
  s_add_u32 s48, s48, s35
  s_lshl_b32 s48, s48, 10
  s_add_u32 s48, s48, s41
  s_add_u32 s35, s35, 1
  s_cmp_ge_u32 s35, s32
  s_cselect_b32 s49, 6, 0
  s_add_u32 s49, s49, s35
  s_lshl_b32 s49, s49, 10
  s_add_u32 s49, s49, s41
  s_add_u32 s35, s35, 1
  s_add_u32 m0, 98304, s46
  s_nop 0
  buffer_load_dwordx4 v8, s[8:11], s48 offen lds
  s_add_u32 m0, m0, 1024
  s_nop 0
  buffer_load_dwordx4 v8, s[8:11], s49 offen lds
  s_add_u32 m0, m0, 1024
  s_nop 0
  buffer_load_dwordx4 v9, s[8:11], s48 offen lds
  s_add_u32 m0, m0, 1024
  s_nop 0
  buffer_load_dwordx4 v9, s[8:11], s49 offen lds
  s_cmp_ge_u32 s34, s32
  s_cselect_b32 s45, 6, 0
  s_add_u32 s45, s45, s34
  s_add_u32 s34, s34, 2
  s_mul_i32 s45, s45, 65536
  s_add_u32 s45, s45, s42
  s_add_u32 m0, 98304, s47
  s_nop 0
  buffer_load_dwordx4 v10, s[12:15], s45 offen lds
  s_add_u32 m0, m0, 1024
  s_nop 0
  buffer_load_dwordx4 v11, s[12:15], s45 offen lds
  s_add_u32 m0, m0, 1024
  s_nop 0
  buffer_load_dwordx4 v12, s[12:15], s45 offen lds
  s_add_u32 m0, m0, 1024
  s_nop 0
  buffer_load_dwordx4 v13, s[12:15], s45 offen lds
  s_waitcnt vmcnt(16)
  s_barrier
  s_cmp_ge_u32 s35, s32
  s_cselect_b32 s48, 6, 0
  s_add_u32 s48, s48, s35
  s_lshl_b32 s48, s48, 10
  s_add_u32 s48, s48, s41
  s_add_u32 s35, s35, 1
  s_cmp_ge_u32 s35, s32
  s_cselect_b32 s49, 6, 0
  s_add_u32 s49, s49, s35
  s_lshl_b32 s49, s49, 10
  s_add_u32 s49, s49, s41
  s_add_u32 s35, s35, 1
  s_add_u32 m0, 0, s46
  s_nop 0
  buffer_load_dwordx4 v8, s[8:11], s48 offen lds
  s_add_u32 m0, m0, 1024
  s_nop 0
  buffer_load_dwordx4 v8, s[8:11], s49 offen lds
  s_add_u32 m0, m0, 1024
  s_nop 0
  buffer_load_dwordx4 v9, s[8:11], s48 offen lds
  s_add_u32 m0, m0, 1024
  s_nop 0
  buffer_load_dwordx4 v9, s[8:11], s49 offen lds
  s_cmp_ge_u32 s34, s32
  s_cselect_b32 s45, 6, 0
  s_add_u32 s45, s45, s34
  s_add_u32 s34, s34, 2
  s_mul_i32 s45, s45, 65536
  s_add_u32 s45, s45, s42
  s_add_u32 m0, 0, s47
  s_nop 0
  buffer_load_dwordx4 v10, s[12:15], s45 offen lds
  s_add_u32 m0, m0, 1024
  s_nop 0
  buffer_load_dwordx4 v11, s[12:15], s45 offen lds
  s_add_u32 m0, m0, 1024
  s_nop 0
  buffer_load_dwordx4 v12, s[12:15], s45 offen lds
  s_add_u32 m0, m0, 1024
  s_nop 0
  buffer_load_dwordx4 v13, s[12:15], s45 offen lds
  s_mov_b32 s39, 32768
  s_mov_b32 s40, 19
w2_lmain:
  s_waitcnt vmcnt(16)
  s_barrier
  s_cmp_ge_u32 s35, s32
  s_cselect_b32 s48, 6, 0
  s_add_u32 s48, s48, s35
  s_lshl_b32 s48, s48, 10
  s_add_u32 s48, s48, s41
  s_add_u32 s35, s35, 1
  s_cmp_ge_u32 s35, s32
  s_cselect_b32 s49, 6, 0
  s_add_u32 s49, s49, s35
  s_lshl_b32 s49, s49, 10
  s_add_u32 s49, s49, s41
  s_add_u32 s35, s35, 1
  s_add_u32 m0, s39, s46
  s_nop 0
  buffer_load_dwordx4 v8, s[8:11], s48 offen lds
  s_add_u32 m0, m0, 1024
  s_nop 0
  buffer_load_dwordx4 v8, s[8:11], s49 offen lds
  s_add_u32 m0, m0, 1024
  s_nop 0
  buffer_load_dwordx4 v9, s[8:11], s48 offen lds
  s_add_u32 m0, m0, 1024
  s_nop 0
  buffer_load_dwordx4 v9, s[8:11], s49 offen lds
  s_cmp_ge_u32 s34, s32
  s_cselect_b32 s45, 6, 0
  s_add_u32 s45, s45, s34
  s_add_u32 s34, s34, 2
  s_mul_i32 s45, s45, 65536
  s_add_u32 s45, s45, s42
  s_add_u32 m0, s39, s47
  s_nop 0
  buffer_load_dwordx4 v10, s[12:15], s45 offen lds
  s_add_u32 m0, m0, 1024
  s_nop 0
  buffer_load_dwordx4 v11, s[12:15], s45 offen lds
  s_add_u32 m0, m0, 1024
  s_nop 0
  buffer_load_dwordx4 v12, s[12:15], s45 offen lds
  s_add_u32 m0, m0, 1024
  s_nop 0
  buffer_load_dwordx4 v13, s[12:15], s45 offen lds
  s_add_u32 s39, s39, 32768
  s_cmp_eq_u32 s39, 131072
  s_cselect_b32 s39, 0, s39
  s_sub_u32 s40, s40, 1
  s_cmp_lg_u32 s40, 0
  s_cbranch_scc1 w2_lmain
  s_waitcnt vmcnt(16)
  s_barrier
  s_waitcnt vmcnt(8)
  s_barrier
  s_waitcnt vmcnt(0)
  s_barrier
sequential_preLN__mha_block__dense_activation_gelu__prompt_kernel_end:
  s_endpgm
sequential_preLN__mha_block__dense_activation_gelu__prompt_kernel_codeend:
.section .rodata,"a"
.p2align 6
.amdhsa_kernel sequential_preLN__mha_block__dense_activation_gelu__prompt_kernel
  .amdhsa_next_free_vgpr 256
  .amdhsa_next_free_sgpr 102
  .amdhsa_accum_offset 256
  .amdhsa_group_segment_fixed_size 0
  .amdhsa_kernarg_size 88
  .amdhsa_user_sgpr_count 2
  .amdhsa_user_sgpr_kernarg_segment_ptr 1
  .amdhsa_system_sgpr_workgroup_id_x 1
.end_amdhsa_kernel
.text
```
